```python
import torch

def _softmax(x, axis=-1):
    return torch.softmax(x, dim=axis)

def _gelu(x):
    return torch.nn.functional.gelu(x, approximate='tanh')

def _silu(x):
    return torch.nn.functional.silu(x)

def _sigmoid(x):
    return torch.sigmoid(x)

def _layernorm(x, axis=-1, eps=1e-05):
    m = x.mean(dim=axis, keepdim=True)
    v = x.var(dim=axis, keepdim=True, unbiased=False)
    return (x - m) / torch.sqrt(v + eps)

def _scatter_add(tgt, idx, src, axis=0):
    return tgt.clone().index_add_(axis, idx, src)

def _segment_sum(src, seg, n):
    out = torch.zeros((n,) + src.shape[1:], dtype=src.dtype)
    return out.index_add_(0, seg, src)

def _pad(x, pw):
    flat = tuple((v for pair in reversed(pw) for v in pair))
    return torch.nn.functional.pad(x, flat)
kernel_name = 'interleave_layers__ssm_conv_h3__mixer_gmlp__prompt'

def setup_inputs():

    _w = lambda a: (lambda t: t.to(torch.bfloat16) if t.is_floating_point() else t)(torch.as_tensor(a))

    def _A_setup():
        B, S, D = (1, 2048, 640)
        ks = 4
        return {'q': _w((lambda *s: torch.randn(*s, dtype=torch.bfloat16) * 0.05)(B, S, D)), 'k': _w((lambda *s: torch.randn(*s, dtype=torch.bfloat16) * 1.6)(B, S, D)), 'v': _w((lambda *s: torch.randn(*s, dtype=torch.bfloat16) * 1.6)(B, S, D)), 'shift_k': _w((lambda *s: torch.randn(*s, dtype=torch.bfloat16) * 1.6)(D, ks) * 0.5), 'ssm_k': _w((lambda *s: torch.randn(*s, dtype=torch.bfloat16) * 1.6)(D, S) * (1.0 / S ** 0.5)), 'ssm_D': _w((lambda *s: torch.randn(*s, dtype=torch.bfloat16) * 1.6)(D))}
    _A_in = _A_setup()

    def _B_setup():
        B, S, D, F = (1, 2048, 640, 1728)
        Fh = F // 2
        return {'x': _w((lambda *s: torch.randn(*s, dtype=torch.bfloat16) * 0.05)(B, S, D)), 'w_in': _w((lambda *s: torch.randn(*s, dtype=torch.bfloat16) * 1.6)(D, 2 * Fh)), 'w_sp': _w(0.01 * (lambda *s: torch.randn(*s, dtype=torch.bfloat16) * 1.6)(S, S)), 'b_sp': _w(1.0 + 0.01 * (lambda *s: torch.randn(*s, dtype=torch.bfloat16) * 0.2)(S)), 'w_out': _w((lambda *s: torch.randn(*s, dtype=torch.bfloat16) * 0.2)(Fh, D))}
    _B_in = _B_setup()
    return {'A_q': _A_in['q'], 'A_k': _A_in['k'], 'A_v': _A_in['v'], 'A_shift_k': _A_in['shift_k'], 'A_ssm_k': _A_in['ssm_k'], 'A_ssm_D': _A_in['ssm_D'], 'B_x': _B_in['x'], 'B_w_in': _B_in['w_in'], 'B_w_sp': _B_in['w_sp'], 'B_b_sp': _B_in['b_sp'], 'B_w_out': _B_in['w_out']}

def reference(A_q, A_k, A_v, A_shift_k, A_ssm_k, A_ssm_D, B_x, B_w_in, B_w_sp, B_b_sp, B_w_out):

    def _A_ref(q, k, v, shift_k, ssm_k, ssm_D):
        B, S, D = q.shape
        ks = shift_k.shape[-1]
        k_pad = _pad(k, ((0, 0), (ks - 1, 0), (0, 0)))
        k_shift = torch.zeros_like(k)
        for t in range(ks):
            k_shift = k_shift + k_pad[:, t:t + S, :] * shift_k[:, ks - 1 - t][None, None, :]
        kv = k_shift * v
        L = 2 * S
        kv_pad = _pad(kv, ((0, 0), (0, S), (0, 0)))
        kf_pad = _pad(ssm_k, ((0, 0), (0, S)))
        kv_f = (lambda x, axes=(-2, -1): torch.fft.rfft2(x.float(), dim=axes))(kv_pad[:, None, :, :], axes=(1, 2))
        kf_f = (lambda x, axes=(-2, -1): torch.fft.rfft2(x.float(), dim=axes))(kf_pad[:, None, :], axes=(1, 2))
        kf_f = (lambda x, *d: x.permute(*d))(kf_f, 1, 2, 0)
        y_f = kv_f * kf_f[None, :, :, :]
        y = (lambda x, s, axes=(-2, -1): torch.fft.irfft2(x, s=s, dim=axes).to(torch.bfloat16))(y_f, (1, L), axes=(1, 2))[:, 0, :S, :]
        y = y + kv * ssm_D[None, None, :]
        return q * y

    def _B_ref(x, w_in, w_sp, b_sp, w_out):
        B, S, D = x.shape
        F = w_in.shape[-1]
        Fh = F // 2
        z = _gelu(torch.einsum('bsd,df->bsf', x, w_in))
        z1 = z[..., :Fh].clone()
        z2 = _layernorm(z[..., Fh:], axis=-1)
        g = torch.einsum('ts,bsf->btf', w_sp, z2) + b_sp[None, :, None]
        return torch.einsum('bsf,fd->bsd', z1 * g, w_out)
    x = A_q
    x = x + _A_ref(_layernorm(x, axis=-1), A_k, A_v, A_shift_k, A_ssm_k, A_ssm_D)
    x = x + _B_ref(_layernorm(x, axis=-1), B_w_in, B_w_sp, B_b_sp, B_w_out)
    x = x + _A_ref(_layernorm(x, axis=-1), A_k, A_v, A_shift_k, A_ssm_k, A_ssm_D)
    x = x + _B_ref(_layernorm(x, axis=-1), B_w_in, B_w_sp, B_b_sp, B_w_out)
    return x
```

```asm
; @launch kernel=prep_kernel grid=(1460,1,1) block=(256,1,1) lds=5120
; @launch kernel=conv_kernel grid=(640,1,1) block=(256,1,1) lds=36864
; @launch kernel=rowa_kernel grid=(256,1,1) block=(512,1,1) lds=16384
; @launch kernel=gemm1_kernel grid=(224,1,1) block=(512,1,1) lds=131072
; @launch kernel=lnz_kernel grid=(256,1,1) block=(512,1,1) lds=16384
; @launch kernel=gemm2_kernel grid=(224,1,1) block=(512,1,1) lds=98304
; @launch kernel=gemm3a_kernel grid=(160,1,1) block=(512,1,1) lds=98304
; @launch kernel=rowb_kernel grid=(256,1,1) block=(512,1,1) lds=16384
; @launch kernel=gemm1_kernel grid=(224,1,1) block=(512,1,1) lds=131072
; @launch kernel=lnz_kernel grid=(256,1,1) block=(512,1,1) lds=16384
; @launch kernel=gemm2_kernel grid=(224,1,1) block=(512,1,1) lds=98304
; @launch kernel=gemm3b_kernel grid=(160,1,1) block=(512,1,1) lds=98304
.amdgcn_target "amdgcn-amd-amdhsa--gfx950"
.text
.globl prep_kernel
.p2align 8
.type prep_kernel,@function
prep_kernel:
    s_cmp_ge_u32 s2, 1460
    s_cbranch_scc1 prep_done
    s_load_dwordx2 s[4:5], s[0:1], 8
    s_load_dwordx2 s[6:7], s[0:1], 16
    s_load_dwordx2 s[8:9], s[0:1], 24
    s_load_dwordx2 s[10:11], s[0:1], 56
    s_load_dwordx2 s[12:13], s[0:1], 80
    s_load_dwordx2 s[14:15], s[0:1], 104
    v_lshrrev_b32 v1, 3, v0
    v_and_b32 v2, 7, v0
    s_waitcnt lgkmcnt(0)
    s_cmp_ge_u32 s2, 640
    s_cbranch_scc1 prep_tr
    s_mov_b32 s16, 429496730
    s_mul_hi_u32 s17, s2, s16
    s_mul_i32 s18, s17, 10
    s_sub_u32 s18, s2, s18
    s_lshl_b32 s19, s17, 5
    s_lshl_b32 s20, s18, 6
    s_mov_b32 s24, s4
    s_mov_b32 s25, s5
    s_mov_b32 s26, 2621440
    s_mov_b32 s27, 0x00020000
    s_mov_b32 s28, s6
    s_mov_b32 s29, s7
    s_mov_b32 s30, 2621440
    s_mov_b32 s31, 0x00020000
    s_mov_b32 s32, s8
    s_mov_b32 s33, s9
    s_mov_b32 s34, 5120
    s_mov_b32 s35, 0x00020000
    s_mov_b32 s36, s14
    s_mov_b32 s37, s15
    s_mov_b32 s38, 2785280
    s_mov_b32 s39, 0x00020000
    v_add_u32 v3, s19, v1
    v_mul_u32_u24 v3, 1280, v3
    v_lshlrev_b32 v4, 4, v2
    v_add_u32 v3, v3, v4
    s_lshl_b32 s21, s20, 1
    v_add_u32 v3, s21, v3
    v_subrev_u32 v5, 1280, v3
    v_subrev_u32 v6, 2560, v3
    v_subrev_u32 v7, 3840, v3
    buffer_load_dwordx4 v[8:11], v3, s[24:27], 0 offen
    buffer_load_dwordx4 v[12:15], v5, s[24:27], 0 offen
    buffer_load_dwordx4 v[16:19], v6, s[24:27], 0 offen
    buffer_load_dwordx4 v[20:23], v7, s[24:27], 0 offen
    buffer_load_dwordx4 v[24:27], v3, s[28:31], 0 offen
    v_lshlrev_b32 v4, 6, v2
    s_lshl_b32 s21, s20, 3
    v_add_u32 v4, s21, v4
    buffer_load_dwordx4 v[28:31], v4, s[32:35], 0 offen
    buffer_load_dwordx4 v[32:35], v4, s[32:35], 0 offen offset:16
    buffer_load_dwordx4 v[36:39], v4, s[32:35], 0 offen offset:32
    buffer_load_dwordx4 v[40:43], v4, s[32:35], 0 offen offset:48
    v_mul_u32_u24 v44, 640, v2
    v_sub_u32 v45, 31, v1
    v_lshlrev_b32 v45, 1, v45
    v_add_u32 v44, v44, v45
    s_waitcnt vmcnt(0)
    v_lshlrev_b32 v50, 16, v8
    v_lshlrev_b32 v51, 16, v12
    v_lshlrev_b32 v52, 16, v16
    v_lshlrev_b32 v53, 16, v20
    v_lshlrev_b32 v54, 16, v24
    v_lshlrev_b32 v55, 16, v28
    v_and_b32 v56, 0xffff0000, v28
    v_lshlrev_b32 v57, 16, v29
    v_and_b32 v58, 0xffff0000, v29
    v_mul_f32 v60, v53, v58
    v_mul_f32 v61, v52, v57
    v_cvt_pk_bf16_f32 v62, v60, v61
    v_lshlrev_b32 v60, 16, v62
    v_and_b32 v61, 0xffff0000, v62
    v_add_f32 v60, v60, v61
    v_mul_f32 v61, v51, v56
    v_cvt_pk_bf16_f32 v62, v60, v61
    v_lshlrev_b32 v60, 16, v62
    v_and_b32 v61, 0xffff0000, v62
    v_add_f32 v60, v60, v61
    v_mul_f32 v61, v50, v55
    v_cvt_pk_bf16_f32 v62, v60, v61
    v_lshlrev_b32 v60, 16, v62
    v_and_b32 v61, 0xffff0000, v62
    v_add_f32 v60, v60, v61
    v_cvt_pk_bf16_f32 v62, v60, v60
    v_lshlrev_b32 v60, 16, v62
    v_mul_f32 v60, v60, v54
    v_cvt_pk_bf16_f32 v62, v60, v60
    ds_write_b16 v44, v62 offset:0
    v_and_b32 v50, 0xffff0000, v8
    v_and_b32 v51, 0xffff0000, v12
    v_and_b32 v52, 0xffff0000, v16
    v_and_b32 v53, 0xffff0000, v20
    v_and_b32 v54, 0xffff0000, v24
    v_lshlrev_b32 v55, 16, v30
    v_and_b32 v56, 0xffff0000, v30
    v_lshlrev_b32 v57, 16, v31
    v_and_b32 v58, 0xffff0000, v31
    v_mul_f32 v60, v53, v58
    v_mul_f32 v61, v52, v57
    v_cvt_pk_bf16_f32 v62, v60, v61
    v_lshlrev_b32 v60, 16, v62
    v_and_b32 v61, 0xffff0000, v62
    v_add_f32 v60, v60, v61
    v_mul_f32 v61, v51, v56
    v_cvt_pk_bf16_f32 v62, v60, v61
    v_lshlrev_b32 v60, 16, v62
    v_and_b32 v61, 0xffff0000, v62
    v_add_f32 v60, v60, v61
    v_mul_f32 v61, v50, v55
    v_cvt_pk_bf16_f32 v62, v60, v61
    v_lshlrev_b32 v60, 16, v62
    v_and_b32 v61, 0xffff0000, v62
    v_add_f32 v60, v60, v61
    v_cvt_pk_bf16_f32 v62, v60, v60
    v_lshlrev_b32 v60, 16, v62
    v_mul_f32 v60, v60, v54
    v_cvt_pk_bf16_f32 v62, v60, v60
    ds_write_b16 v44, v62 offset:80
    v_lshlrev_b32 v50, 16, v9
    v_lshlrev_b32 v51, 16, v13
    v_lshlrev_b32 v52, 16, v17
    v_lshlrev_b32 v53, 16, v21
    v_lshlrev_b32 v54, 16, v25
    v_lshlrev_b32 v55, 16, v32
    v_and_b32 v56, 0xffff0000, v32
    v_lshlrev_b32 v57, 16, v33
    v_and_b32 v58, 0xffff0000, v33
    v_mul_f32 v60, v53, v58
    v_mul_f32 v61, v52, v57
    v_cvt_pk_bf16_f32 v62, v60, v61
    v_lshlrev_b32 v60, 16, v62
    v_and_b32 v61, 0xffff0000, v62
    v_add_f32 v60, v60, v61
    v_mul_f32 v61, v51, v56
    v_cvt_pk_bf16_f32 v62, v60, v61
    v_lshlrev_b32 v60, 16, v62
    v_and_b32 v61, 0xffff0000, v62
    v_add_f32 v60, v60, v61
    v_mul_f32 v61, v50, v55
    v_cvt_pk_bf16_f32 v62, v60, v61
    v_lshlrev_b32 v60, 16, v62
    v_and_b32 v61, 0xffff0000, v62
    v_add_f32 v60, v60, v61
    v_cvt_pk_bf16_f32 v62, v60, v60
    v_lshlrev_b32 v60, 16, v62
    v_mul_f32 v60, v60, v54
    v_cvt_pk_bf16_f32 v62, v60, v60
    ds_write_b16 v44, v62 offset:160
    v_and_b32 v50, 0xffff0000, v9
    v_and_b32 v51, 0xffff0000, v13
    v_and_b32 v52, 0xffff0000, v17
    v_and_b32 v53, 0xffff0000, v21
    v_and_b32 v54, 0xffff0000, v25
    v_lshlrev_b32 v55, 16, v34
    v_and_b32 v56, 0xffff0000, v34
    v_lshlrev_b32 v57, 16, v35
    v_and_b32 v58, 0xffff0000, v35
    v_mul_f32 v60, v53, v58
    v_mul_f32 v61, v52, v57
    v_cvt_pk_bf16_f32 v62, v60, v61
    v_lshlrev_b32 v60, 16, v62
    v_and_b32 v61, 0xffff0000, v62
    v_add_f32 v60, v60, v61
    v_mul_f32 v61, v51, v56
    v_cvt_pk_bf16_f32 v62, v60, v61
    v_lshlrev_b32 v60, 16, v62
    v_and_b32 v61, 0xffff0000, v62
    v_add_f32 v60, v60, v61
    v_mul_f32 v61, v50, v55
    v_cvt_pk_bf16_f32 v62, v60, v61
    v_lshlrev_b32 v60, 16, v62
    v_and_b32 v61, 0xffff0000, v62
    v_add_f32 v60, v60, v61
    v_cvt_pk_bf16_f32 v62, v60, v60
    v_lshlrev_b32 v60, 16, v62
    v_mul_f32 v60, v60, v54
    v_cvt_pk_bf16_f32 v62, v60, v60
    ds_write_b16 v44, v62 offset:240
    v_lshlrev_b32 v50, 16, v10
    v_lshlrev_b32 v51, 16, v14
    v_lshlrev_b32 v52, 16, v18
    v_lshlrev_b32 v53, 16, v22
    v_lshlrev_b32 v54, 16, v26
    v_lshlrev_b32 v55, 16, v36
    v_and_b32 v56, 0xffff0000, v36
    v_lshlrev_b32 v57, 16, v37
    v_and_b32 v58, 0xffff0000, v37
    v_mul_f32 v60, v53, v58
    v_mul_f32 v61, v52, v57
    v_cvt_pk_bf16_f32 v62, v60, v61
    v_lshlrev_b32 v60, 16, v62
    v_and_b32 v61, 0xffff0000, v62
    v_add_f32 v60, v60, v61
    v_mul_f32 v61, v51, v56
    v_cvt_pk_bf16_f32 v62, v60, v61
    v_lshlrev_b32 v60, 16, v62
    v_and_b32 v61, 0xffff0000, v62
    v_add_f32 v60, v60, v61
    v_mul_f32 v61, v50, v55
    v_cvt_pk_bf16_f32 v62, v60, v61
    v_lshlrev_b32 v60, 16, v62
    v_and_b32 v61, 0xffff0000, v62
    v_add_f32 v60, v60, v61
    v_cvt_pk_bf16_f32 v62, v60, v60
    v_lshlrev_b32 v60, 16, v62
    v_mul_f32 v60, v60, v54
    v_cvt_pk_bf16_f32 v62, v60, v60
    ds_write_b16 v44, v62 offset:320
    v_and_b32 v50, 0xffff0000, v10
    v_and_b32 v51, 0xffff0000, v14
    v_and_b32 v52, 0xffff0000, v18
    v_and_b32 v53, 0xffff0000, v22
    v_and_b32 v54, 0xffff0000, v26
    v_lshlrev_b32 v55, 16, v38
    v_and_b32 v56, 0xffff0000, v38
    v_lshlrev_b32 v57, 16, v39
    v_and_b32 v58, 0xffff0000, v39
    v_mul_f32 v60, v53, v58
    v_mul_f32 v61, v52, v57
    v_cvt_pk_bf16_f32 v62, v60, v61
    v_lshlrev_b32 v60, 16, v62
    v_and_b32 v61, 0xffff0000, v62
    v_add_f32 v60, v60, v61
    v_mul_f32 v61, v51, v56
    v_cvt_pk_bf16_f32 v62, v60, v61
    v_lshlrev_b32 v60, 16, v62
    v_and_b32 v61, 0xffff0000, v62
    v_add_f32 v60, v60, v61
    v_mul_f32 v61, v50, v55
    v_cvt_pk_bf16_f32 v62, v60, v61
    v_lshlrev_b32 v60, 16, v62
    v_and_b32 v61, 0xffff0000, v62
    v_add_f32 v60, v60, v61
    v_cvt_pk_bf16_f32 v62, v60, v60
    v_lshlrev_b32 v60, 16, v62
    v_mul_f32 v60, v60, v54
    v_cvt_pk_bf16_f32 v62, v60, v60
    ds_write_b16 v44, v62 offset:400
    v_lshlrev_b32 v50, 16, v11
    v_lshlrev_b32 v51, 16, v15
    v_lshlrev_b32 v52, 16, v19
    v_lshlrev_b32 v53, 16, v23
    v_lshlrev_b32 v54, 16, v27
    v_lshlrev_b32 v55, 16, v40
    v_and_b32 v56, 0xffff0000, v40
    v_lshlrev_b32 v57, 16, v41
    v_and_b32 v58, 0xffff0000, v41
    v_mul_f32 v60, v53, v58
    v_mul_f32 v61, v52, v57
    v_cvt_pk_bf16_f32 v62, v60, v61
    v_lshlrev_b32 v60, 16, v62
    v_and_b32 v61, 0xffff0000, v62
    v_add_f32 v60, v60, v61
    v_mul_f32 v61, v51, v56
    v_cvt_pk_bf16_f32 v62, v60, v61
    v_lshlrev_b32 v60, 16, v62
    v_and_b32 v61, 0xffff0000, v62
    v_add_f32 v60, v60, v61
    v_mul_f32 v61, v50, v55
    v_cvt_pk_bf16_f32 v62, v60, v61
    v_lshlrev_b32 v60, 16, v62
    v_and_b32 v61, 0xffff0000, v62
    v_add_f32 v60, v60, v61
    v_cvt_pk_bf16_f32 v62, v60, v60
    v_lshlrev_b32 v60, 16, v62
    v_mul_f32 v60, v60, v54
    v_cvt_pk_bf16_f32 v62, v60, v60
    ds_write_b16 v44, v62 offset:480
    v_and_b32 v50, 0xffff0000, v11
    v_and_b32 v51, 0xffff0000, v15
    v_and_b32 v52, 0xffff0000, v19
    v_and_b32 v53, 0xffff0000, v23
    v_and_b32 v54, 0xffff0000, v27
    v_lshlrev_b32 v55, 16, v42
    v_and_b32 v56, 0xffff0000, v42
    v_lshlrev_b32 v57, 16, v43
    v_and_b32 v58, 0xffff0000, v43
    v_mul_f32 v60, v53, v58
    v_mul_f32 v61, v52, v57
    v_cvt_pk_bf16_f32 v62, v60, v61
    v_lshlrev_b32 v60, 16, v62
    v_and_b32 v61, 0xffff0000, v62
    v_add_f32 v60, v60, v61
    v_mul_f32 v61, v51, v56
    v_cvt_pk_bf16_f32 v62, v60, v61
    v_lshlrev_b32 v60, 16, v62
    v_and_b32 v61, 0xffff0000, v62
    v_add_f32 v60, v60, v61
    v_mul_f32 v61, v50, v55
    v_cvt_pk_bf16_f32 v62, v60, v61
    v_lshlrev_b32 v60, 16, v62
    v_and_b32 v61, 0xffff0000, v62
    v_add_f32 v60, v60, v61
    v_cvt_pk_bf16_f32 v62, v60, v60
    v_lshlrev_b32 v60, 16, v62
    v_mul_f32 v60, v60, v54
    v_cvt_pk_bf16_f32 v62, v60, v60
    ds_write_b16 v44, v62 offset:560
    s_waitcnt lgkmcnt(0)
    s_barrier
    v_lshrrev_b32 v45, 2, v0
    v_and_b32 v46, 3, v0
    v_mul_u32_u24 v47, 80, v45
    v_lshlrev_b32 v48, 4, v46
    v_add_u32 v47, v47, v48
    ds_read_b128 v[8:11], v47
    v_add_u32 v45, s20, v45
    v_mul_u32_u24 v45, 4352, v45
    s_sub_u32 s21, 2016, s19
    s_lshl_b32 s21, s21, 1
    v_add_u32 v45, s21, v45
    v_add_u32 v45, v45, v48
    s_waitcnt lgkmcnt(0)
    buffer_store_dwordx4 v[8:11], v45, s[36:39], 0 offen
    s_branch prep_done
prep_tr:
    s_sub_u32 s16, s2, 640
    s_cmp_ge_u32 s16, 540
    s_cbranch_scc1 prep_tr2
    s_mov_b32 s17, 159072863
    s_mul_hi_u32 s18, s16, s17
    s_mul_i32 s19, s18, 27
    s_sub_u32 s19, s16, s19
    s_mov_b32 s20, 640
    s_mov_b32 s21, 1728
    s_mov_b32 s24, s10
    s_mov_b32 s25, s11
    s_mov_b32 s26, 2211840
    s_mov_b32 s27, 0x00020000
    s_add_u32 s28, s14, 6291456
    s_addc_u32 s29, s15, 0
    s_mov_b32 s30, 2211840
    s_mov_b32 s31, 0x00020000
    s_branch prep_tr3
prep_tr2:
    s_sub_u32 s16, s16, 540
    s_mov_b32 s17, 429496730
    s_mul_hi_u32 s18, s16, s17
    s_mul_i32 s19, s18, 10
    s_sub_u32 s19, s16, s19
    s_mov_b32 s20, 896
    s_mov_b32 s21, 640
    s_mov_b32 s24, s12
    s_mov_b32 s25, s13
    s_mov_b32 s26, 1105920
    s_mov_b32 s27, 0x00020000
    s_add_u32 s28, s14, 9437184
    s_addc_u32 s29, s15, 0
    s_mov_b32 s30, 1146880
    s_mov_b32 s31, 0x00020000
prep_tr3:
    s_lshl_b32 s22, s18, 5
    s_lshl_b32 s23, s19, 6
    v_add_u32 v3, s22, v1
    v_mul_lo_u32 v3, v3, s21
    v_lshlrev_b32 v4, 3, v2
    v_add_u32 v3, v3, v4
    v_add_u32 v3, s23, v3
    v_lshlrev_b32 v3, 1, v3
    buffer_load_dwordx4 v[8:11], v3, s[24:27], 0 offen
    v_mul_u32_u24 v44, 640, v2
    v_lshlrev_b32 v45, 1, v1
    v_add_u32 v44, v44, v45
    s_waitcnt vmcnt(0)
    ds_write_b16 v44, v8 offset:0
    ds_write_b16_d16_hi v44, v8 offset:80
    ds_write_b16 v44, v9 offset:160
    ds_write_b16_d16_hi v44, v9 offset:240
    ds_write_b16 v44, v10 offset:320
    ds_write_b16_d16_hi v44, v10 offset:400
    ds_write_b16 v44, v11 offset:480
    ds_write_b16_d16_hi v44, v11 offset:560
    s_waitcnt lgkmcnt(0)
    s_barrier
    v_lshrrev_b32 v45, 2, v0
    v_and_b32 v46, 3, v0
    v_mul_u32_u24 v47, 80, v45
    v_lshlrev_b32 v48, 4, v46
    v_add_u32 v47, v47, v48
    ds_read_b128 v[8:11], v47
    v_add_u32 v45, s23, v45
    v_mul_lo_u32 v45, v45, s20
    v_add_u32 v45, s22, v45
    v_lshlrev_b32 v45, 1, v45
    v_add_u32 v45, v45, v48
    s_waitcnt lgkmcnt(0)
    buffer_store_dwordx4 v[8:11], v45, s[28:31], 0 offen
prep_done:
    s_endpgm
.globl conv_kernel
.p2align 8
.type conv_kernel,@function
conv_kernel:
    s_cmp_ge_u32 s2, 640
    s_cbranch_scc1 conv_done
    s_load_dwordx2 s[4:5], s[0:1], 32
    s_load_dwordx2 s[6:7], s[0:1], 40
    s_load_dwordx2 s[14:15], s[0:1], 104
    s_lshl_b32 s16, s2, 12
    v_lshrrev_b32 v1, 6, v0
    s_nop 0
    v_readfirstlane_b32 s22, v1
    s_waitcnt lgkmcnt(0)
    s_add_u32 s4, s4, s16
    s_addc_u32 s5, s5, 0
    s_mul_i32 s16, s2, 4352
    s_add_u32 s8, s14, s16
    s_addc_u32 s9, s15, 0
    s_mov_b32 s24, s4
    s_mov_b32 s25, s5
    s_mov_b32 s26, 4096
    s_mov_b32 s27, 0x00020000
    s_mov_b32 s28, s8
    s_mov_b32 s29, s9
    s_mov_b32 s30, 4096
    s_mov_b32 s31, 0x00020000
    s_add_u32 s32, s14, 3145728
    s_addc_u32 s33, s15, 0
    s_mov_b32 s34, 2621440
    s_mov_b32 s35, 0x00020000
    s_mov_b32 s36, s6
    s_mov_b32 s37, s7
    s_mov_b32 s38, 1280
    s_mov_b32 s39, 0x00020000
    v_lshlrev_b32 v3, 4, v0
    v_subrev_u32 v4, 128, v3
    v_subrev_u32 v5, 112, v3
    buffer_load_dwordx4 v[8:11], v4, s[24:27], 0 offen
    buffer_load_dwordx4 v[12:15], v5, s[24:27], 0 offen
    v_add_u32 v6, 4096, v3
    v_subrev_u32 v4, 128, v6
    v_subrev_u32 v5, 112, v6
    buffer_load_dwordx4 v[16:19], v4, s[24:27], 0 offen
    buffer_load_dwordx4 v[20:23], v5, s[24:27], 0 offen
    v_subrev_u32 v4, 16, v3
    buffer_load_dwordx4 v[24:27], v4, s[28:31], 0 offen
    buffer_load_dwordx4 v[28:31], v3, s[28:31], 0 offen
    s_lshl_b32 s17, s2, 1
    v_mov_b32 v4, s17
    buffer_load_ushort v39, v4, s[36:39], 0 offen
    v_lshrrev_b32 v5, 3, v0
    v_lshlrev_b32 v5, 4, v5
    v_add_u32 v7, v3, v5
    v_mov_b32 v32, 0
    v_mov_b32 v33, 0
    v_mov_b32 v34, 0
    v_mov_b32 v35, 0
    ds_write_b128 v7, v[32:35] offset:22144
    v_cmp_ne_u32 vcc, 0, v0
    s_and_saveexec_b64 s[40:41], vcc
    ds_write_b128 v7, v[32:35] offset:31424
    s_mov_b64 exec, s[40:41]
    s_waitcnt vmcnt(5)
    v_alignbit_b32 v40, v9, v8, 16
    v_alignbit_b32 v41, v10, v9, 16
    v_alignbit_b32 v42, v11, v10, 16
    v_alignbit_b32 v43, v12, v11, 16
    ds_write_b128 v3, v[40:43] offset:0
    v_alignbit_b32 v44, v10, v9, 16
    v_alignbit_b32 v45, v11, v10, 16
    v_alignbit_b32 v46, v12, v11, 16
    v_alignbit_b32 v47, v13, v12, 16
    ds_write_b128 v3, v[44:47] offset:4384
    v_alignbit_b32 v40, v11, v10, 16
    v_alignbit_b32 v41, v12, v11, 16
    v_alignbit_b32 v42, v13, v12, 16
    v_alignbit_b32 v43, v14, v13, 16
    ds_write_b128 v3, v[40:43] offset:8768
    v_alignbit_b32 v44, v12, v11, 16
    v_alignbit_b32 v45, v13, v12, 16
    v_alignbit_b32 v46, v14, v13, 16
    v_alignbit_b32 v47, v15, v14, 16
    ds_write_b128 v3, v[44:47] offset:13152
    s_waitcnt vmcnt(3)
    v_cmp_gt_u32 vcc, 16, v0
    s_and_saveexec_b64 s[40:41], vcc
    v_alignbit_b32 v40, v17, v16, 16
    v_alignbit_b32 v41, v18, v17, 16
    v_alignbit_b32 v42, v19, v18, 16
    v_alignbit_b32 v43, v20, v19, 16
    ds_write_b128 v6, v[40:43] offset:0
    v_alignbit_b32 v44, v18, v17, 16
    v_alignbit_b32 v45, v19, v18, 16
    v_alignbit_b32 v46, v20, v19, 16
    v_alignbit_b32 v47, v21, v20, 16
    ds_write_b128 v6, v[44:47] offset:4384
    v_alignbit_b32 v40, v19, v18, 16
    v_alignbit_b32 v41, v20, v19, 16
    v_alignbit_b32 v42, v21, v20, 16
    v_alignbit_b32 v43, v22, v21, 16
    ds_write_b128 v6, v[40:43] offset:8768
    v_alignbit_b32 v44, v20, v19, 16
    v_alignbit_b32 v45, v21, v20, 16
    v_alignbit_b32 v46, v22, v21, 16
    v_alignbit_b32 v47, v23, v22, 16
    ds_write_b128 v6, v[44:47] offset:13152
    s_mov_b64 exec, s[40:41]
    s_waitcnt vmcnt(0)
    ds_write_b128 v7, v[28:31] offset:17536
    v_alignbit_b32 v40, v28, v27, 16
    v_alignbit_b32 v41, v29, v28, 16
    v_alignbit_b32 v42, v30, v29, 16
    v_alignbit_b32 v43, v31, v30, 16
    ds_write_b128 v7, v[40:43] offset:26816
    v_lshrrev_b32 v44, 16, v31
    v_mov_b32 v45, 0
    v_mov_b32 v46, 0
    v_mov_b32 v47, 0
    v_cmp_eq_u32 vcc, 255, v0
    s_and_saveexec_b64 s[40:41], vcc
    v_mov_b32 v5, 31424
    ds_write_b128 v5, v[44:47]
    s_mov_b64 exec, s[40:41]
    v_lshlrev_b32 v39, 16, v39
    v_and_b32 v2, 63, v0
    v_and_b32 v3, 31, v2
    v_lshrrev_b32 v4, 5, v2
    s_mul_i32 s42, s22, 24
    s_cmp_eq_u32 s22, 3
    s_cselect_b32 s42, 76, s42
    s_lshl_b32 s43, s42, 5
    v_lshlrev_b32 v5, 1, v3
    v_add_u32 v5, 1, v5
    v_and_b32 v6, 7, v5
    v_lshrrev_b32 v6, 1, v6
    v_mul_u32_u24 v6, 4384, v6
    v_and_b32 v5, 0x78, v5
    v_lshl_add_u32 v5, v4, 3, v5
    v_lshl_add_u32 v36, v5, 1, v6
    v_add_u32 v36, s43, v36
    v_and_b32 v5, 15, v2
    v_bfe_u32 v6, v2, 4, 1
    v_mul_u32_u24 v6, 9280, v6
    v_mul_u32_u24 v5, 144, v5
    v_sub_u32 v5, 22000, v5
    v_add_u32 v5, v5, v6
    v_lshl_add_u32 v5, v4, 4, v5
    s_lshr_b32 s44, s42, 2
    s_lshl_b32 s44, s44, 4
    s_add_u32 s44, s44, s43
    v_add_u32 v37, s44, v5
    v_subrev_u32 v38, 2304, v37
    v_mov_b32 v64, 0
    v_mov_b32 v65, 0
    v_mov_b32 v66, 0
    v_mov_b32 v67, 0
    v_mov_b32 v68, 0
    v_mov_b32 v69, 0
    v_mov_b32 v70, 0
    v_mov_b32 v71, 0
    v_mov_b32 v72, 0
    v_mov_b32 v73, 0
    v_mov_b32 v74, 0
    v_mov_b32 v75, 0
    v_mov_b32 v76, 0
    v_mov_b32 v77, 0
    v_mov_b32 v78, 0
    v_mov_b32 v79, 0
    v_mov_b32 v80, 0
    v_mov_b32 v81, 0
    v_mov_b32 v82, 0
    v_mov_b32 v83, 0
    v_mov_b32 v84, 0
    v_mov_b32 v85, 0
    v_mov_b32 v86, 0
    v_mov_b32 v87, 0
    v_mov_b32 v88, 0
    v_mov_b32 v89, 0
    v_mov_b32 v90, 0
    v_mov_b32 v91, 0
    v_mov_b32 v92, 0
    v_mov_b32 v93, 0
    v_mov_b32 v94, 0
    v_mov_b32 v95, 0
    s_waitcnt lgkmcnt(0)
    s_barrier
    s_mov_b32 s45, 6
    s_cmp_eq_u32 s22, 2
    s_cselect_b32 s45, 5, s45
    s_cmp_eq_u32 s22, 3
    s_cselect_b32 s45, 0, s45
    s_mov_b32 s46, 0
    s_cmp_eq_u32 s22, 2
    s_cselect_b32 s46, 2, s46
    s_cmp_eq_u32 s22, 3
    s_cselect_b32 s46, 14, s46
    s_cmp_eq_u32 s45, 0
    s_cbranch_scc1 conv_lb
conv_la:
    ds_read_b128 v[40:43], v36 offset:0
    ds_read_b128 v[44:47], v37 offset:0
    ds_read_b128 v[48:51], v38 offset:0
    ds_read_b128 v[52:55], v36 offset:32
    ds_read_b128 v[56:59], v37 offset:32
    ds_read_b128 v[60:63], v38 offset:32
    s_waitcnt lgkmcnt(3)
    v_mfma_f32_32x32x16_bf16 v[64:79], v[40:43], v[44:47], v[64:79]
    v_mfma_f32_32x32x16_bf16 v[80:95], v[40:43], v[48:51], v[80:95]
    ds_read_b128 v[40:43], v36 offset:64
    ds_read_b128 v[44:47], v37 offset:64
    ds_read_b128 v[48:51], v38 offset:64
    s_waitcnt lgkmcnt(3)
    v_mfma_f32_32x32x16_bf16 v[64:79], v[52:55], v[56:59], v[64:79]
    v_mfma_f32_32x32x16_bf16 v[80:95], v[52:55], v[60:63], v[80:95]
    ds_read_b128 v[52:55], v36 offset:96
    ds_read_b128 v[56:59], v37 offset:96
    ds_read_b128 v[60:63], v38 offset:96
    s_waitcnt lgkmcnt(3)
    v_mfma_f32_32x32x16_bf16 v[64:79], v[40:43], v[44:47], v[64:79]
    v_mfma_f32_32x32x16_bf16 v[80:95], v[40:43], v[48:51], v[80:95]
    v_add_u32 v36, 128, v36
    v_add_u32 v37, 144, v37
    v_add_u32 v38, 144, v38
    s_waitcnt lgkmcnt(0)
    v_mfma_f32_32x32x16_bf16 v[64:79], v[52:55], v[56:59], v[64:79]
    v_mfma_f32_32x32x16_bf16 v[80:95], v[52:55], v[60:63], v[80:95]
    s_sub_u32 s45, s45, 1
    s_cmp_lg_u32 s45, 0
    s_cbranch_scc1 conv_la
conv_lb:
    s_cmp_eq_u32 s46, 0
    s_cbranch_scc1 conv_le
conv_lb2:
    ds_read_b128 v[8:11], v36 offset:0
    ds_read_b128 v[12:15], v38 offset:0
    ds_read_b128 v[16:19], v36 offset:32
    ds_read_b128 v[20:23], v38 offset:32
    ds_read_b128 v[24:27], v36 offset:64
    ds_read_b128 v[28:31], v38 offset:64
    ds_read_b128 v[40:43], v36 offset:96
    ds_read_b128 v[44:47], v38 offset:96
    v_add_u32 v36, 128, v36
    v_add_u32 v38, 144, v38
    s_waitcnt lgkmcnt(6)
    v_mfma_f32_32x32x16_bf16 v[80:95], v[8:11], v[12:15], v[80:95]
    s_waitcnt lgkmcnt(4)
    v_mfma_f32_32x32x16_bf16 v[80:95], v[16:19], v[20:23], v[80:95]
    s_waitcnt lgkmcnt(2)
    v_mfma_f32_32x32x16_bf16 v[80:95], v[24:27], v[28:31], v[80:95]
    s_waitcnt lgkmcnt(0)
    v_mfma_f32_32x32x16_bf16 v[80:95], v[40:43], v[44:47], v[80:95]
    s_sub_u32 s46, s46, 1
    s_cmp_lg_u32 s46, 0
    s_cbranch_scc1 conv_lb2
conv_le:
    v_sub_u32 v6, 255, v0
    v_lshrrev_b32 v7, 3, v6
    v_add_u32 v6, v6, v7
    v_lshlrev_b32 v6, 4, v6
    ds_read_b128 v[8:11], v6 offset:17536
    s_waitcnt lgkmcnt(0)
    s_barrier
    s_nop 7
    s_mul_i32 s43, s22, 9216
    v_mul_u32_u24 v5, 144, v3
    v_lshl_add_u32 v5, v4, 4, v5
    v_add_u32 v5, s43, v5
    ds_write_b128 v5, v[64:67] offset:0
    ds_write_b128 v5, v[68:71] offset:32
    ds_write_b128 v5, v[72:75] offset:64
    ds_write_b128 v5, v[76:79] offset:96
    ds_write_b128 v5, v[80:83] offset:4608
    ds_write_b128 v5, v[84:87] offset:4640
    ds_write_b128 v5, v[88:91] offset:4672
    ds_write_b128 v5, v[92:95] offset:4704
    v_lshrrev_b32 v5, 3, v0
    v_and_b32 v6, 15, v5
    v_lshrrev_b32 v7, 4, v5
    v_lshl_add_u32 v6, v7, 5, v6
    v_mul_u32_u24 v6, 144, v6
    v_and_b32 v7, 7, v0
    v_lshl_add_u32 v5, v7, 4, v6
    s_waitcnt lgkmcnt(0)
    s_barrier
    ds_read_b128 v[40:43], v5 offset:0
    ds_read_b128 v[44:47], v5 offset:2304
    ds_read_b128 v[48:51], v5 offset:9216
    ds_read_b128 v[52:55], v5 offset:11520
    ds_read_b128 v[56:59], v5 offset:18432
    ds_read_b128 v[60:63], v5 offset:20736
    ds_read_b128 v[64:67], v5 offset:27648
    ds_read_b128 v[68:71], v5 offset:29952
    s_waitcnt lgkmcnt(0)
    v_pk_add_f32 v[40:41], v[40:41], v[48:49]
    v_pk_add_f32 v[56:57], v[56:57], v[64:65]
    v_pk_add_f32 v[40:41], v[40:41], v[56:57]
    v_pk_add_f32 v[42:43], v[42:43], v[50:51]
    v_pk_add_f32 v[58:59], v[58:59], v[66:67]
    v_pk_add_f32 v[42:43], v[42:43], v[58:59]
    v_pk_add_f32 v[44:45], v[44:45], v[52:53]
    v_pk_add_f32 v[60:61], v[60:61], v[68:69]
    v_pk_add_f32 v[44:45], v[44:45], v[60:61]
    v_pk_add_f32 v[46:47], v[46:47], v[54:55]
    v_pk_add_f32 v[62:63], v[62:63], v[70:71]
    v_pk_add_f32 v[46:47], v[46:47], v[62:63]
    v_cvt_pk_bf16_f32 v12, v40, v44
    v_lshlrev_b32 v40, 16, v12
    v_and_b32 v44, 0xffff0000, v12
    v_and_b32 v13, 0xffff0000, v11
    v_lshlrev_b32 v14, 16, v11
    v_mul_f32 v13, v13, v39
    v_mul_f32 v14, v14, v39
    v_cvt_pk_bf16_f32 v12, v13, v14
    v_lshlrev_b32 v13, 16, v12
    v_and_b32 v14, 0xffff0000, v12
    v_add_f32 v13, v13, v40
    v_add_f32 v14, v14, v44
    v_cvt_pk_bf16_f32 v16, v13, v14
    v_cvt_pk_bf16_f32 v12, v41, v45
    v_lshlrev_b32 v41, 16, v12
    v_and_b32 v45, 0xffff0000, v12
    v_and_b32 v13, 0xffff0000, v10
    v_lshlrev_b32 v14, 16, v10
    v_mul_f32 v13, v13, v39
    v_mul_f32 v14, v14, v39
    v_cvt_pk_bf16_f32 v12, v13, v14
    v_lshlrev_b32 v13, 16, v12
    v_and_b32 v14, 0xffff0000, v12
    v_add_f32 v13, v13, v41
    v_add_f32 v14, v14, v45
    v_cvt_pk_bf16_f32 v17, v13, v14
    v_cvt_pk_bf16_f32 v12, v42, v46
    v_lshlrev_b32 v42, 16, v12
    v_and_b32 v46, 0xffff0000, v12
    v_and_b32 v13, 0xffff0000, v9
    v_lshlrev_b32 v14, 16, v9
    v_mul_f32 v13, v13, v39
    v_mul_f32 v14, v14, v39
    v_cvt_pk_bf16_f32 v12, v13, v14
    v_lshlrev_b32 v13, 16, v12
    v_and_b32 v14, 0xffff0000, v12
    v_add_f32 v13, v13, v42
    v_add_f32 v14, v14, v46
    v_cvt_pk_bf16_f32 v18, v13, v14
    v_cvt_pk_bf16_f32 v12, v43, v47
    v_lshlrev_b32 v43, 16, v12
    v_and_b32 v47, 0xffff0000, v12
    v_and_b32 v13, 0xffff0000, v8
    v_lshlrev_b32 v14, 16, v8
    v_mul_f32 v13, v13, v39
    v_mul_f32 v14, v14, v39
    v_cvt_pk_bf16_f32 v12, v13, v14
    v_lshlrev_b32 v13, 16, v12
    v_and_b32 v14, 0xffff0000, v12
    v_add_f32 v13, v13, v43
    v_add_f32 v14, v14, v47
    v_cvt_pk_bf16_f32 v19, v13, v14
    v_mul_u32_u24 v3, 10240, v0
    s_lshl_b32 s16, s2, 4
    v_add_u32 v3, s16, v3
    buffer_store_dwordx4 v[16:19], v3, s[32:35], 0 offen
conv_done:
    s_endpgm
.globl rowa_kernel
.p2align 8
.type rowa_kernel,@function
rowa_kernel:
    s_cmp_ge_u32 s2, 256
    s_cbranch_scc1 rowa_kernel_done
    s_load_dwordx2 s[4:5], s[0:1], 0
    s_load_dwordx2 s[14:15], s[0:1], 104
    v_lshrrev_b32 v1, 6, v0
    v_and_b32 v2, 63, v0
    s_lshl_b32 s17, s2, 3
    v_add_u32 v3, s17, v1
    v_mul_u32_u24 v3, 1280, v3
    v_lshl_add_u32 v3, v2, 2, v3
    s_waitcnt lgkmcnt(0)
    s_mov_b32 s24, s4
    s_mov_b32 s25, s5
    s_mov_b32 s26, 2621440
    s_mov_b32 s27, 0x00020000
    s_add_u32 s28, s14, 3145728
    s_addc_u32 s29, s15, 0
    s_mov_b32 s30, 2621440
    s_mov_b32 s31, 0x00020000
    s_add_u32 s32, s14, 11534336
    s_addc_u32 s33, s15, 0
    s_mov_b32 s34, 2621440
    s_mov_b32 s35, 0x00020000
    s_add_u32 s36, s14, 20971520
    s_addc_u32 s37, s15, 0
    s_mov_b32 s38, 2621440
    s_mov_b32 s39, 0x00020000
    buffer_load_dword v8, v3, s[24:27], 0 offen offset:0
    buffer_load_dword v9, v3, s[24:27], 0 offen offset:256
    buffer_load_dword v10, v3, s[24:27], 0 offen offset:512
    buffer_load_dword v11, v3, s[24:27], 0 offen offset:768
    buffer_load_dword v12, v3, s[24:27], 0 offen offset:1024
    s_mul_i32 s16, s2, 10240
    v_lshlrev_b32 v6, 4, v0
    v_add_u32 v4, s16, v6
    v_cmp_gt_u32 vcc, 128, v0
    v_add_u32 v5, 8192, v4
    s_nop 0
    v_cndmask_b32 v5, -1, v5, vcc
    buffer_load_dwordx4 v[16:19], v4, s[28:31], 0 offen
    buffer_load_dwordx4 v[20:23], v5, s[28:31], 0 offen
    s_waitcnt vmcnt(0)
    ds_write_b128 v6, v[16:19]
    ds_write_b128 v6, v[20:23] offset:8192
    v_lshlrev_b32 v4, 5, v2
    v_lshl_add_u32 v4, v1, 1, v4
    v_lshlrev_b32 v16, 16, v8
    v_and_b32 v17, 0xffff0000, v8
    v_lshlrev_b32 v18, 16, v9
    v_and_b32 v19, 0xffff0000, v9
    v_lshlrev_b32 v20, 16, v10
    v_and_b32 v21, 0xffff0000, v10
    v_lshlrev_b32 v22, 16, v11
    v_and_b32 v23, 0xffff0000, v11
    v_lshlrev_b32 v24, 16, v12
    v_and_b32 v25, 0xffff0000, v12
    s_waitcnt lgkmcnt(0)
    s_barrier
    ds_read_u16 v40, v4 offset:0
    ds_read_u16 v41, v4 offset:16
    ds_read_u16 v42, v4 offset:2048
    ds_read_u16 v43, v4 offset:2064
    ds_read_u16 v44, v4 offset:4096
    ds_read_u16 v45, v4 offset:4112
    ds_read_u16 v46, v4 offset:6144
    ds_read_u16 v47, v4 offset:6160
    ds_read_u16 v48, v4 offset:8192
    ds_read_u16 v49, v4 offset:8208
    v_pk_add_f32 v[52:53], v[16:17], v[18:19]
    v_pk_add_f32 v[52:53], v[52:53], v[20:21]
    v_pk_add_f32 v[52:53], v[52:53], v[22:23]
    v_pk_add_f32 v[52:53], v[52:53], v[24:25]
    v_add_f32 v52, v52, v53
    s_nop 1
    v_add_f32_dpp v53, v52, v52 quad_perm:[1,0,3,2] row_mask:0xf bank_mask:0xf
    s_nop 1
    v_add_f32_dpp v52, v53, v53 quad_perm:[2,3,0,1] row_mask:0xf bank_mask:0xf
    s_nop 1
    v_add_f32_dpp v53, v52, v52 row_half_mirror row_mask:0xf bank_mask:0xf
    s_nop 1
    v_add_f32_dpp v52, v53, v53 row_mirror row_mask:0xf bank_mask:0xf
    s_nop 0
    v_readlane_b32 s52, v52, 16
    v_readlane_b32 s53, v52, 32
    v_readlane_b32 s54, v52, 48
    s_nop 1
    v_add_f32 v52, s52, v52
    v_add_f32 v52, s53, v52
    v_add_f32 v52, s54, v52
    s_nop 0
    v_readlane_b32 s50, v52, 0
    s_nop 1
    v_mov_b32 v52, 0.0015625
    v_mul_f32 v54, s50, v52
    v_mul_f32 v55, s50, v52
    v_mov_b32 v56, 0
    v_mov_b32 v57, 0
    v_pk_add_f32 v[52:53], v[16:17], v[54:55] neg_lo:[0,1] neg_hi:[0,1]
    v_pk_fma_f32 v[56:57], v[52:53], v[52:53], v[56:57]
    v_pk_add_f32 v[52:53], v[18:19], v[54:55] neg_lo:[0,1] neg_hi:[0,1]
    v_pk_fma_f32 v[56:57], v[52:53], v[52:53], v[56:57]
    v_pk_add_f32 v[52:53], v[20:21], v[54:55] neg_lo:[0,1] neg_hi:[0,1]
    v_pk_fma_f32 v[56:57], v[52:53], v[52:53], v[56:57]
    v_pk_add_f32 v[52:53], v[22:23], v[54:55] neg_lo:[0,1] neg_hi:[0,1]
    v_pk_fma_f32 v[56:57], v[52:53], v[52:53], v[56:57]
    v_pk_add_f32 v[52:53], v[24:25], v[54:55] neg_lo:[0,1] neg_hi:[0,1]
    v_pk_fma_f32 v[56:57], v[52:53], v[52:53], v[56:57]
    v_add_f32 v52, v56, v57
    s_nop 1
    v_add_f32_dpp v53, v52, v52 quad_perm:[1,0,3,2] row_mask:0xf bank_mask:0xf
    s_nop 1
    v_add_f32_dpp v52, v53, v53 quad_perm:[2,3,0,1] row_mask:0xf bank_mask:0xf
    s_nop 1
    v_add_f32_dpp v53, v52, v52 row_half_mirror row_mask:0xf bank_mask:0xf
    s_nop 1
    v_add_f32_dpp v52, v53, v53 row_mirror row_mask:0xf bank_mask:0xf
    s_nop 0
    v_readlane_b32 s52, v52, 16
    v_readlane_b32 s53, v52, 32
    v_readlane_b32 s54, v52, 48
    s_nop 1
    v_add_f32 v52, s52, v52
    v_add_f32 v52, s53, v52
    v_add_f32 v52, s54, v52
    s_nop 0
    v_readlane_b32 s51, v52, 0
    s_nop 1
    v_mov_b32 v52, 0.0015625
    v_mul_f32 v56, s51, v52
    v_cvt_pk_bf16_f32 v52, v54, v56
    v_lshlrev_b32 v54, 16, v52
    v_and_b32 v56, 0xffff0000, v52
    v_mov_b32 v55, v54
    v_add_f32 v56, 0x3727c5ac, v56
    v_cvt_pk_bf16_f32 v52, v56, v56
    v_lshlrev_b32 v56, 16, v52
    v_sqrt_f32 v56, v56
    s_nop 0
    v_cvt_pk_bf16_f32 v52, v56, v56
    v_lshlrev_b32 v56, 16, v52
    v_rcp_f32 v58, v56
    s_nop 0
    v_fma_f32 v52, -v56, v58, 2.0
    v_mul_f32 v58, v58, v52
    v_mov_b32 v59, v58
    v_pk_add_f32 v[28:29], v[16:17], v[54:55] neg_lo:[0,1] neg_hi:[0,1]
    v_cvt_pk_bf16_f32 v52, v28, v29
    v_lshlrev_b32 v28, 16, v52
    v_and_b32 v29, 0xffff0000, v52
    v_pk_mul_f32 v[28:29], v[28:29], v[58:59]
    v_pk_add_f32 v[30:31], v[18:19], v[54:55] neg_lo:[0,1] neg_hi:[0,1]
    v_cvt_pk_bf16_f32 v52, v30, v31
    v_lshlrev_b32 v30, 16, v52
    v_and_b32 v31, 0xffff0000, v52
    v_pk_mul_f32 v[30:31], v[30:31], v[58:59]
    v_pk_add_f32 v[32:33], v[20:21], v[54:55] neg_lo:[0,1] neg_hi:[0,1]
    v_cvt_pk_bf16_f32 v52, v32, v33
    v_lshlrev_b32 v32, 16, v52
    v_and_b32 v33, 0xffff0000, v52
    v_pk_mul_f32 v[32:33], v[32:33], v[58:59]
    v_pk_add_f32 v[34:35], v[22:23], v[54:55] neg_lo:[0,1] neg_hi:[0,1]
    v_cvt_pk_bf16_f32 v52, v34, v35
    v_lshlrev_b32 v34, 16, v52
    v_and_b32 v35, 0xffff0000, v52
    v_pk_mul_f32 v[34:35], v[34:35], v[58:59]
    v_pk_add_f32 v[36:37], v[24:25], v[54:55] neg_lo:[0,1] neg_hi:[0,1]
    v_cvt_pk_bf16_f32 v52, v36, v37
    v_lshlrev_b32 v36, 16, v52
    v_and_b32 v37, 0xffff0000, v52
    v_pk_mul_f32 v[36:37], v[36:37], v[58:59]
    s_waitcnt lgkmcnt(0)
    v_lshlrev_b32 v40, 16, v40
    v_lshlrev_b32 v41, 16, v41
    v_lshlrev_b32 v42, 16, v42
    v_lshlrev_b32 v43, 16, v43
    v_lshlrev_b32 v44, 16, v44
    v_lshlrev_b32 v45, 16, v45
    v_lshlrev_b32 v46, 16, v46
    v_lshlrev_b32 v47, 16, v47
    v_lshlrev_b32 v48, 16, v48
    v_lshlrev_b32 v49, 16, v49
    v_cvt_pk_bf16_f32 v56, v28, v29
    v_lshlrev_b32 v28, 16, v56
    v_and_b32 v29, 0xffff0000, v56
    v_pk_mul_f32 v[28:29], v[28:29], v[40:41]
    v_cvt_pk_bf16_f32 v56, v28, v29
    v_lshlrev_b32 v28, 16, v56
    v_and_b32 v29, 0xffff0000, v56
    v_pk_add_f32 v[16:17], v[16:17], v[28:29]
    v_cvt_pk_bf16_f32 v8, v16, v17
    v_lshlrev_b32 v16, 16, v8
    v_and_b32 v17, 0xffff0000, v8
    buffer_store_dword v8, v3, s[32:35], 0 offen offset:0
    v_cvt_pk_bf16_f32 v56, v30, v31
    v_lshlrev_b32 v30, 16, v56
    v_and_b32 v31, 0xffff0000, v56
    v_pk_mul_f32 v[30:31], v[30:31], v[42:43]
    v_cvt_pk_bf16_f32 v56, v30, v31
    v_lshlrev_b32 v30, 16, v56
    v_and_b32 v31, 0xffff0000, v56
    v_pk_add_f32 v[18:19], v[18:19], v[30:31]
    v_cvt_pk_bf16_f32 v9, v18, v19
    v_lshlrev_b32 v18, 16, v9
    v_and_b32 v19, 0xffff0000, v9
    buffer_store_dword v9, v3, s[32:35], 0 offen offset:256
    v_cvt_pk_bf16_f32 v56, v32, v33
    v_lshlrev_b32 v32, 16, v56
    v_and_b32 v33, 0xffff0000, v56
    v_pk_mul_f32 v[32:33], v[32:33], v[44:45]
    v_cvt_pk_bf16_f32 v56, v32, v33
    v_lshlrev_b32 v32, 16, v56
    v_and_b32 v33, 0xffff0000, v56
    v_pk_add_f32 v[20:21], v[20:21], v[32:33]
    v_cvt_pk_bf16_f32 v10, v20, v21
    v_lshlrev_b32 v20, 16, v10
    v_and_b32 v21, 0xffff0000, v10
    buffer_store_dword v10, v3, s[32:35], 0 offen offset:512
    v_cvt_pk_bf16_f32 v56, v34, v35
    v_lshlrev_b32 v34, 16, v56
    v_and_b32 v35, 0xffff0000, v56
    v_pk_mul_f32 v[34:35], v[34:35], v[46:47]
    v_cvt_pk_bf16_f32 v56, v34, v35
    v_lshlrev_b32 v34, 16, v56
    v_and_b32 v35, 0xffff0000, v56
    v_pk_add_f32 v[22:23], v[22:23], v[34:35]
    v_cvt_pk_bf16_f32 v11, v22, v23
    v_lshlrev_b32 v22, 16, v11
    v_and_b32 v23, 0xffff0000, v11
    buffer_store_dword v11, v3, s[32:35], 0 offen offset:768
    v_cvt_pk_bf16_f32 v56, v36, v37
    v_lshlrev_b32 v36, 16, v56
    v_and_b32 v37, 0xffff0000, v56
    v_pk_mul_f32 v[36:37], v[36:37], v[48:49]
    v_cvt_pk_bf16_f32 v56, v36, v37
    v_lshlrev_b32 v36, 16, v56
    v_and_b32 v37, 0xffff0000, v56
    v_pk_add_f32 v[24:25], v[24:25], v[36:37]
    v_cvt_pk_bf16_f32 v12, v24, v25
    v_lshlrev_b32 v24, 16, v12
    v_and_b32 v25, 0xffff0000, v12
    buffer_store_dword v12, v3, s[32:35], 0 offen offset:1024
    v_pk_add_f32 v[52:53], v[16:17], v[18:19]
    v_pk_add_f32 v[52:53], v[52:53], v[20:21]
    v_pk_add_f32 v[52:53], v[52:53], v[22:23]
    v_pk_add_f32 v[52:53], v[52:53], v[24:25]
    v_add_f32 v52, v52, v53
    s_nop 1
    v_add_f32_dpp v53, v52, v52 quad_perm:[1,0,3,2] row_mask:0xf bank_mask:0xf
    s_nop 1
    v_add_f32_dpp v52, v53, v53 quad_perm:[2,3,0,1] row_mask:0xf bank_mask:0xf
    s_nop 1
    v_add_f32_dpp v53, v52, v52 row_half_mirror row_mask:0xf bank_mask:0xf
    s_nop 1
    v_add_f32_dpp v52, v53, v53 row_mirror row_mask:0xf bank_mask:0xf
    s_nop 0
    v_readlane_b32 s52, v52, 16
    v_readlane_b32 s53, v52, 32
    v_readlane_b32 s54, v52, 48
    s_nop 1
    v_add_f32 v52, s52, v52
    v_add_f32 v52, s53, v52
    v_add_f32 v52, s54, v52
    s_nop 0
    v_readlane_b32 s50, v52, 0
    s_nop 1
    v_mov_b32 v52, 0.0015625
    v_mul_f32 v54, s50, v52
    v_mul_f32 v55, s50, v52
    v_mov_b32 v56, 0
    v_mov_b32 v57, 0
    v_pk_add_f32 v[52:53], v[16:17], v[54:55] neg_lo:[0,1] neg_hi:[0,1]
    v_pk_fma_f32 v[56:57], v[52:53], v[52:53], v[56:57]
    v_pk_add_f32 v[52:53], v[18:19], v[54:55] neg_lo:[0,1] neg_hi:[0,1]
    v_pk_fma_f32 v[56:57], v[52:53], v[52:53], v[56:57]
    v_pk_add_f32 v[52:53], v[20:21], v[54:55] neg_lo:[0,1] neg_hi:[0,1]
    v_pk_fma_f32 v[56:57], v[52:53], v[52:53], v[56:57]
    v_pk_add_f32 v[52:53], v[22:23], v[54:55] neg_lo:[0,1] neg_hi:[0,1]
    v_pk_fma_f32 v[56:57], v[52:53], v[52:53], v[56:57]
    v_pk_add_f32 v[52:53], v[24:25], v[54:55] neg_lo:[0,1] neg_hi:[0,1]
    v_pk_fma_f32 v[56:57], v[52:53], v[52:53], v[56:57]
    v_add_f32 v52, v56, v57
    s_nop 1
    v_add_f32_dpp v53, v52, v52 quad_perm:[1,0,3,2] row_mask:0xf bank_mask:0xf
    s_nop 1
    v_add_f32_dpp v52, v53, v53 quad_perm:[2,3,0,1] row_mask:0xf bank_mask:0xf
    s_nop 1
    v_add_f32_dpp v53, v52, v52 row_half_mirror row_mask:0xf bank_mask:0xf
    s_nop 1
    v_add_f32_dpp v52, v53, v53 row_mirror row_mask:0xf bank_mask:0xf
    s_nop 0
    v_readlane_b32 s52, v52, 16
    v_readlane_b32 s53, v52, 32
    v_readlane_b32 s54, v52, 48
    s_nop 1
    v_add_f32 v52, s52, v52
    v_add_f32 v52, s53, v52
    v_add_f32 v52, s54, v52
    s_nop 0
    v_readlane_b32 s51, v52, 0
    s_nop 1
    v_mov_b32 v52, 0.0015625
    v_mul_f32 v56, s51, v52
    v_cvt_pk_bf16_f32 v52, v54, v56
    v_lshlrev_b32 v54, 16, v52
    v_and_b32 v56, 0xffff0000, v52
    v_mov_b32 v55, v54
    v_add_f32 v56, 0x3727c5ac, v56
    v_cvt_pk_bf16_f32 v52, v56, v56
    v_lshlrev_b32 v56, 16, v52
    v_sqrt_f32 v56, v56
    s_nop 0
    v_cvt_pk_bf16_f32 v52, v56, v56
    v_lshlrev_b32 v56, 16, v52
    v_rcp_f32 v58, v56
    s_nop 0
    v_fma_f32 v52, -v56, v58, 2.0
    v_mul_f32 v58, v58, v52
    v_mov_b32 v59, v58
    v_pk_add_f32 v[28:29], v[16:17], v[54:55] neg_lo:[0,1] neg_hi:[0,1]
    v_cvt_pk_bf16_f32 v52, v28, v29
    v_lshlrev_b32 v28, 16, v52
    v_and_b32 v29, 0xffff0000, v52
    v_pk_mul_f32 v[28:29], v[28:29], v[58:59]
    v_pk_add_f32 v[30:31], v[18:19], v[54:55] neg_lo:[0,1] neg_hi:[0,1]
    v_cvt_pk_bf16_f32 v52, v30, v31
    v_lshlrev_b32 v30, 16, v52
    v_and_b32 v31, 0xffff0000, v52
    v_pk_mul_f32 v[30:31], v[30:31], v[58:59]
    v_pk_add_f32 v[32:33], v[20:21], v[54:55] neg_lo:[0,1] neg_hi:[0,1]
    v_cvt_pk_bf16_f32 v52, v32, v33
    v_lshlrev_b32 v32, 16, v52
    v_and_b32 v33, 0xffff0000, v52
    v_pk_mul_f32 v[32:33], v[32:33], v[58:59]
    v_pk_add_f32 v[34:35], v[22:23], v[54:55] neg_lo:[0,1] neg_hi:[0,1]
    v_cvt_pk_bf16_f32 v52, v34, v35
    v_lshlrev_b32 v34, 16, v52
    v_and_b32 v35, 0xffff0000, v52
    v_pk_mul_f32 v[34:35], v[34:35], v[58:59]
    v_pk_add_f32 v[36:37], v[24:25], v[54:55] neg_lo:[0,1] neg_hi:[0,1]
    v_cvt_pk_bf16_f32 v52, v36, v37
    v_lshlrev_b32 v36, 16, v52
    v_and_b32 v37, 0xffff0000, v52
    v_pk_mul_f32 v[36:37], v[36:37], v[58:59]
    v_cvt_pk_bf16_f32 v40, v28, v29
    buffer_store_dword v40, v3, s[36:39], 0 offen offset:0
    v_cvt_pk_bf16_f32 v41, v30, v31
    buffer_store_dword v41, v3, s[36:39], 0 offen offset:256
    v_cvt_pk_bf16_f32 v42, v32, v33
    buffer_store_dword v42, v3, s[36:39], 0 offen offset:512
    v_cvt_pk_bf16_f32 v43, v34, v35
    buffer_store_dword v43, v3, s[36:39], 0 offen offset:768
    v_cvt_pk_bf16_f32 v44, v36, v37
    buffer_store_dword v44, v3, s[36:39], 0 offen offset:1024
rowa_kernel_done:
    s_endpgm
.globl rowb_kernel
.p2align 8
.type rowb_kernel,@function
rowb_kernel:
    s_cmp_ge_u32 s2, 256
    s_cbranch_scc1 rowb_kernel_done
    s_load_dwordx2 s[4:5], s[0:1], 104
    s_load_dwordx2 s[14:15], s[0:1], 104
    v_lshrrev_b32 v1, 6, v0
    v_and_b32 v2, 63, v0
    s_lshl_b32 s17, s2, 3
    v_add_u32 v3, s17, v1
    v_mul_u32_u24 v3, 1280, v3
    v_lshl_add_u32 v3, v2, 2, v3
    s_waitcnt lgkmcnt(0)
    s_add_u32 s24, s4, 14680064
    s_addc_u32 s25, s5, 0
    s_mov_b32 s26, 2621440
    s_mov_b32 s27, 0x00020000
    s_add_u32 s28, s14, 3145728
    s_addc_u32 s29, s15, 0
    s_mov_b32 s30, 2621440
    s_mov_b32 s31, 0x00020000
    s_add_u32 s32, s14, 17825792
    s_addc_u32 s33, s15, 0
    s_mov_b32 s34, 2621440
    s_mov_b32 s35, 0x00020000
    s_add_u32 s36, s14, 20971520
    s_addc_u32 s37, s15, 0
    s_mov_b32 s38, 2621440
    s_mov_b32 s39, 0x00020000
    buffer_load_dword v8, v3, s[24:27], 0 offen offset:0
    buffer_load_dword v9, v3, s[24:27], 0 offen offset:256
    buffer_load_dword v10, v3, s[24:27], 0 offen offset:512
    buffer_load_dword v11, v3, s[24:27], 0 offen offset:768
    buffer_load_dword v12, v3, s[24:27], 0 offen offset:1024
    s_mul_i32 s16, s2, 10240
    v_lshlrev_b32 v6, 4, v0
    v_add_u32 v4, s16, v6
    v_cmp_gt_u32 vcc, 128, v0
    v_add_u32 v5, 8192, v4
    s_nop 0
    v_cndmask_b32 v5, -1, v5, vcc
    buffer_load_dwordx4 v[16:19], v4, s[28:31], 0 offen
    buffer_load_dwordx4 v[20:23], v5, s[28:31], 0 offen
    s_waitcnt vmcnt(0)
    ds_write_b128 v6, v[16:19]
    ds_write_b128 v6, v[20:23] offset:8192
    v_lshlrev_b32 v4, 5, v2
    v_lshl_add_u32 v4, v1, 1, v4
    v_lshlrev_b32 v16, 16, v8
    v_and_b32 v17, 0xffff0000, v8
    v_lshlrev_b32 v18, 16, v9
    v_and_b32 v19, 0xffff0000, v9
    v_lshlrev_b32 v20, 16, v10
    v_and_b32 v21, 0xffff0000, v10
    v_lshlrev_b32 v22, 16, v11
    v_and_b32 v23, 0xffff0000, v11
    v_lshlrev_b32 v24, 16, v12
    v_and_b32 v25, 0xffff0000, v12
    s_waitcnt lgkmcnt(0)
    s_barrier
    ds_read_u16 v40, v4 offset:0
    ds_read_u16 v41, v4 offset:16
    ds_read_u16 v42, v4 offset:2048
    ds_read_u16 v43, v4 offset:2064
    ds_read_u16 v44, v4 offset:4096
    ds_read_u16 v45, v4 offset:4112
    ds_read_u16 v46, v4 offset:6144
    ds_read_u16 v47, v4 offset:6160
    ds_read_u16 v48, v4 offset:8192
    ds_read_u16 v49, v4 offset:8208
    v_pk_add_f32 v[52:53], v[16:17], v[18:19]
    v_pk_add_f32 v[52:53], v[52:53], v[20:21]
    v_pk_add_f32 v[52:53], v[52:53], v[22:23]
    v_pk_add_f32 v[52:53], v[52:53], v[24:25]
    v_add_f32 v52, v52, v53
    s_nop 1
    v_add_f32_dpp v53, v52, v52 quad_perm:[1,0,3,2] row_mask:0xf bank_mask:0xf
    s_nop 1
    v_add_f32_dpp v52, v53, v53 quad_perm:[2,3,0,1] row_mask:0xf bank_mask:0xf
    s_nop 1
    v_add_f32_dpp v53, v52, v52 row_half_mirror row_mask:0xf bank_mask:0xf
    s_nop 1
    v_add_f32_dpp v52, v53, v53 row_mirror row_mask:0xf bank_mask:0xf
    s_nop 0
    v_readlane_b32 s52, v52, 16
    v_readlane_b32 s53, v52, 32
    v_readlane_b32 s54, v52, 48
    s_nop 1
    v_add_f32 v52, s52, v52
    v_add_f32 v52, s53, v52
    v_add_f32 v52, s54, v52
    s_nop 0
    v_readlane_b32 s50, v52, 0
    s_nop 1
    v_mov_b32 v52, 0.0015625
    v_mul_f32 v54, s50, v52
    v_mul_f32 v55, s50, v52
    v_mov_b32 v56, 0
    v_mov_b32 v57, 0
    v_pk_add_f32 v[52:53], v[16:17], v[54:55] neg_lo:[0,1] neg_hi:[0,1]
    v_pk_fma_f32 v[56:57], v[52:53], v[52:53], v[56:57]
    v_pk_add_f32 v[52:53], v[18:19], v[54:55] neg_lo:[0,1] neg_hi:[0,1]
    v_pk_fma_f32 v[56:57], v[52:53], v[52:53], v[56:57]
    v_pk_add_f32 v[52:53], v[20:21], v[54:55] neg_lo:[0,1] neg_hi:[0,1]
    v_pk_fma_f32 v[56:57], v[52:53], v[52:53], v[56:57]
    v_pk_add_f32 v[52:53], v[22:23], v[54:55] neg_lo:[0,1] neg_hi:[0,1]
    v_pk_fma_f32 v[56:57], v[52:53], v[52:53], v[56:57]
    v_pk_add_f32 v[52:53], v[24:25], v[54:55] neg_lo:[0,1] neg_hi:[0,1]
    v_pk_fma_f32 v[56:57], v[52:53], v[52:53], v[56:57]
    v_add_f32 v52, v56, v57
    s_nop 1
    v_add_f32_dpp v53, v52, v52 quad_perm:[1,0,3,2] row_mask:0xf bank_mask:0xf
    s_nop 1
    v_add_f32_dpp v52, v53, v53 quad_perm:[2,3,0,1] row_mask:0xf bank_mask:0xf
    s_nop 1
    v_add_f32_dpp v53, v52, v52 row_half_mirror row_mask:0xf bank_mask:0xf
    s_nop 1
    v_add_f32_dpp v52, v53, v53 row_mirror row_mask:0xf bank_mask:0xf
    s_nop 0
    v_readlane_b32 s52, v52, 16
    v_readlane_b32 s53, v52, 32
    v_readlane_b32 s54, v52, 48
    s_nop 1
    v_add_f32 v52, s52, v52
    v_add_f32 v52, s53, v52
    v_add_f32 v52, s54, v52
    s_nop 0
    v_readlane_b32 s51, v52, 0
    s_nop 1
    v_mov_b32 v52, 0.0015625
    v_mul_f32 v56, s51, v52
    v_cvt_pk_bf16_f32 v52, v54, v56
    v_lshlrev_b32 v54, 16, v52
    v_and_b32 v56, 0xffff0000, v52
    v_mov_b32 v55, v54
    v_add_f32 v56, 0x3727c5ac, v56
    v_cvt_pk_bf16_f32 v52, v56, v56
    v_lshlrev_b32 v56, 16, v52
    v_sqrt_f32 v56, v56
    s_nop 0
    v_cvt_pk_bf16_f32 v52, v56, v56
    v_lshlrev_b32 v56, 16, v52
    v_rcp_f32 v58, v56
    s_nop 0
    v_fma_f32 v52, -v56, v58, 2.0
    v_mul_f32 v58, v58, v52
    v_mov_b32 v59, v58
    v_pk_add_f32 v[28:29], v[16:17], v[54:55] neg_lo:[0,1] neg_hi:[0,1]
    v_cvt_pk_bf16_f32 v52, v28, v29
    v_lshlrev_b32 v28, 16, v52
    v_and_b32 v29, 0xffff0000, v52
    v_pk_mul_f32 v[28:29], v[28:29], v[58:59]
    v_pk_add_f32 v[30:31], v[18:19], v[54:55] neg_lo:[0,1] neg_hi:[0,1]
    v_cvt_pk_bf16_f32 v52, v30, v31
    v_lshlrev_b32 v30, 16, v52
    v_and_b32 v31, 0xffff0000, v52
    v_pk_mul_f32 v[30:31], v[30:31], v[58:59]
    v_pk_add_f32 v[32:33], v[20:21], v[54:55] neg_lo:[0,1] neg_hi:[0,1]
    v_cvt_pk_bf16_f32 v52, v32, v33
    v_lshlrev_b32 v32, 16, v52
    v_and_b32 v33, 0xffff0000, v52
    v_pk_mul_f32 v[32:33], v[32:33], v[58:59]
    v_pk_add_f32 v[34:35], v[22:23], v[54:55] neg_lo:[0,1] neg_hi:[0,1]
    v_cvt_pk_bf16_f32 v52, v34, v35
    v_lshlrev_b32 v34, 16, v52
    v_and_b32 v35, 0xffff0000, v52
    v_pk_mul_f32 v[34:35], v[34:35], v[58:59]
    v_pk_add_f32 v[36:37], v[24:25], v[54:55] neg_lo:[0,1] neg_hi:[0,1]
    v_cvt_pk_bf16_f32 v52, v36, v37
    v_lshlrev_b32 v36, 16, v52
    v_and_b32 v37, 0xffff0000, v52
    v_pk_mul_f32 v[36:37], v[36:37], v[58:59]
    s_waitcnt lgkmcnt(0)
    v_lshlrev_b32 v40, 16, v40
    v_lshlrev_b32 v41, 16, v41
    v_lshlrev_b32 v42, 16, v42
    v_lshlrev_b32 v43, 16, v43
    v_lshlrev_b32 v44, 16, v44
    v_lshlrev_b32 v45, 16, v45
    v_lshlrev_b32 v46, 16, v46
    v_lshlrev_b32 v47, 16, v47
    v_lshlrev_b32 v48, 16, v48
    v_lshlrev_b32 v49, 16, v49
    v_cvt_pk_bf16_f32 v56, v28, v29
    v_lshlrev_b32 v28, 16, v56
    v_and_b32 v29, 0xffff0000, v56
    v_pk_mul_f32 v[28:29], v[28:29], v[40:41]
    v_cvt_pk_bf16_f32 v56, v28, v29
    v_lshlrev_b32 v28, 16, v56
    v_and_b32 v29, 0xffff0000, v56
    v_pk_add_f32 v[16:17], v[16:17], v[28:29]
    v_cvt_pk_bf16_f32 v8, v16, v17
    v_lshlrev_b32 v16, 16, v8
    v_and_b32 v17, 0xffff0000, v8
    buffer_store_dword v8, v3, s[32:35], 0 offen offset:0
    v_cvt_pk_bf16_f32 v56, v30, v31
    v_lshlrev_b32 v30, 16, v56
    v_and_b32 v31, 0xffff0000, v56
    v_pk_mul_f32 v[30:31], v[30:31], v[42:43]
    v_cvt_pk_bf16_f32 v56, v30, v31
    v_lshlrev_b32 v30, 16, v56
    v_and_b32 v31, 0xffff0000, v56
    v_pk_add_f32 v[18:19], v[18:19], v[30:31]
    v_cvt_pk_bf16_f32 v9, v18, v19
    v_lshlrev_b32 v18, 16, v9
    v_and_b32 v19, 0xffff0000, v9
    buffer_store_dword v9, v3, s[32:35], 0 offen offset:256
    v_cvt_pk_bf16_f32 v56, v32, v33
    v_lshlrev_b32 v32, 16, v56
    v_and_b32 v33, 0xffff0000, v56
    v_pk_mul_f32 v[32:33], v[32:33], v[44:45]
    v_cvt_pk_bf16_f32 v56, v32, v33
    v_lshlrev_b32 v32, 16, v56
    v_and_b32 v33, 0xffff0000, v56
    v_pk_add_f32 v[20:21], v[20:21], v[32:33]
    v_cvt_pk_bf16_f32 v10, v20, v21
    v_lshlrev_b32 v20, 16, v10
    v_and_b32 v21, 0xffff0000, v10
    buffer_store_dword v10, v3, s[32:35], 0 offen offset:512
    v_cvt_pk_bf16_f32 v56, v34, v35
    v_lshlrev_b32 v34, 16, v56
    v_and_b32 v35, 0xffff0000, v56
    v_pk_mul_f32 v[34:35], v[34:35], v[46:47]
    v_cvt_pk_bf16_f32 v56, v34, v35
    v_lshlrev_b32 v34, 16, v56
    v_and_b32 v35, 0xffff0000, v56
    v_pk_add_f32 v[22:23], v[22:23], v[34:35]
    v_cvt_pk_bf16_f32 v11, v22, v23
    v_lshlrev_b32 v22, 16, v11
    v_and_b32 v23, 0xffff0000, v11
    buffer_store_dword v11, v3, s[32:35], 0 offen offset:768
    v_cvt_pk_bf16_f32 v56, v36, v37
    v_lshlrev_b32 v36, 16, v56
    v_and_b32 v37, 0xffff0000, v56
    v_pk_mul_f32 v[36:37], v[36:37], v[48:49]
    v_cvt_pk_bf16_f32 v56, v36, v37
    v_lshlrev_b32 v36, 16, v56
    v_and_b32 v37, 0xffff0000, v56
    v_pk_add_f32 v[24:25], v[24:25], v[36:37]
    v_cvt_pk_bf16_f32 v12, v24, v25
    v_lshlrev_b32 v24, 16, v12
    v_and_b32 v25, 0xffff0000, v12
    buffer_store_dword v12, v3, s[32:35], 0 offen offset:1024
    v_pk_add_f32 v[52:53], v[16:17], v[18:19]
    v_pk_add_f32 v[52:53], v[52:53], v[20:21]
    v_pk_add_f32 v[52:53], v[52:53], v[22:23]
    v_pk_add_f32 v[52:53], v[52:53], v[24:25]
    v_add_f32 v52, v52, v53
    s_nop 1
    v_add_f32_dpp v53, v52, v52 quad_perm:[1,0,3,2] row_mask:0xf bank_mask:0xf
    s_nop 1
    v_add_f32_dpp v52, v53, v53 quad_perm:[2,3,0,1] row_mask:0xf bank_mask:0xf
    s_nop 1
    v_add_f32_dpp v53, v52, v52 row_half_mirror row_mask:0xf bank_mask:0xf
    s_nop 1
    v_add_f32_dpp v52, v53, v53 row_mirror row_mask:0xf bank_mask:0xf
    s_nop 0
    v_readlane_b32 s52, v52, 16
    v_readlane_b32 s53, v52, 32
    v_readlane_b32 s54, v52, 48
    s_nop 1
    v_add_f32 v52, s52, v52
    v_add_f32 v52, s53, v52
    v_add_f32 v52, s54, v52
    s_nop 0
    v_readlane_b32 s50, v52, 0
    s_nop 1
    v_mov_b32 v52, 0.0015625
    v_mul_f32 v54, s50, v52
    v_mul_f32 v55, s50, v52
    v_mov_b32 v56, 0
    v_mov_b32 v57, 0
    v_pk_add_f32 v[52:53], v[16:17], v[54:55] neg_lo:[0,1] neg_hi:[0,1]
    v_pk_fma_f32 v[56:57], v[52:53], v[52:53], v[56:57]
    v_pk_add_f32 v[52:53], v[18:19], v[54:55] neg_lo:[0,1] neg_hi:[0,1]
    v_pk_fma_f32 v[56:57], v[52:53], v[52:53], v[56:57]
    v_pk_add_f32 v[52:53], v[20:21], v[54:55] neg_lo:[0,1] neg_hi:[0,1]
    v_pk_fma_f32 v[56:57], v[52:53], v[52:53], v[56:57]
    v_pk_add_f32 v[52:53], v[22:23], v[54:55] neg_lo:[0,1] neg_hi:[0,1]
    v_pk_fma_f32 v[56:57], v[52:53], v[52:53], v[56:57]
    v_pk_add_f32 v[52:53], v[24:25], v[54:55] neg_lo:[0,1] neg_hi:[0,1]
    v_pk_fma_f32 v[56:57], v[52:53], v[52:53], v[56:57]
    v_add_f32 v52, v56, v57
    s_nop 1
    v_add_f32_dpp v53, v52, v52 quad_perm:[1,0,3,2] row_mask:0xf bank_mask:0xf
    s_nop 1
    v_add_f32_dpp v52, v53, v53 quad_perm:[2,3,0,1] row_mask:0xf bank_mask:0xf
    s_nop 1
    v_add_f32_dpp v53, v52, v52 row_half_mirror row_mask:0xf bank_mask:0xf
    s_nop 1
    v_add_f32_dpp v52, v53, v53 row_mirror row_mask:0xf bank_mask:0xf
    s_nop 0
    v_readlane_b32 s52, v52, 16
    v_readlane_b32 s53, v52, 32
    v_readlane_b32 s54, v52, 48
    s_nop 1
    v_add_f32 v52, s52, v52
    v_add_f32 v52, s53, v52
    v_add_f32 v52, s54, v52
    s_nop 0
    v_readlane_b32 s51, v52, 0
    s_nop 1
    v_mov_b32 v52, 0.0015625
    v_mul_f32 v56, s51, v52
    v_cvt_pk_bf16_f32 v52, v54, v56
    v_lshlrev_b32 v54, 16, v52
    v_and_b32 v56, 0xffff0000, v52
    v_mov_b32 v55, v54
    v_add_f32 v56, 0x3727c5ac, v56
    v_cvt_pk_bf16_f32 v52, v56, v56
    v_lshlrev_b32 v56, 16, v52
    v_sqrt_f32 v56, v56
    s_nop 0
    v_cvt_pk_bf16_f32 v52, v56, v56
    v_lshlrev_b32 v56, 16, v52
    v_rcp_f32 v58, v56
    s_nop 0
    v_fma_f32 v52, -v56, v58, 2.0
    v_mul_f32 v58, v58, v52
    v_mov_b32 v59, v58
    v_pk_add_f32 v[28:29], v[16:17], v[54:55] neg_lo:[0,1] neg_hi:[0,1]
    v_cvt_pk_bf16_f32 v52, v28, v29
    v_lshlrev_b32 v28, 16, v52
    v_and_b32 v29, 0xffff0000, v52
    v_pk_mul_f32 v[28:29], v[28:29], v[58:59]
    v_pk_add_f32 v[30:31], v[18:19], v[54:55] neg_lo:[0,1] neg_hi:[0,1]
    v_cvt_pk_bf16_f32 v52, v30, v31
    v_lshlrev_b32 v30, 16, v52
    v_and_b32 v31, 0xffff0000, v52
    v_pk_mul_f32 v[30:31], v[30:31], v[58:59]
    v_pk_add_f32 v[32:33], v[20:21], v[54:55] neg_lo:[0,1] neg_hi:[0,1]
    v_cvt_pk_bf16_f32 v52, v32, v33
    v_lshlrev_b32 v32, 16, v52
    v_and_b32 v33, 0xffff0000, v52
    v_pk_mul_f32 v[32:33], v[32:33], v[58:59]
    v_pk_add_f32 v[34:35], v[22:23], v[54:55] neg_lo:[0,1] neg_hi:[0,1]
    v_cvt_pk_bf16_f32 v52, v34, v35
    v_lshlrev_b32 v34, 16, v52
    v_and_b32 v35, 0xffff0000, v52
    v_pk_mul_f32 v[34:35], v[34:35], v[58:59]
    v_pk_add_f32 v[36:37], v[24:25], v[54:55] neg_lo:[0,1] neg_hi:[0,1]
    v_cvt_pk_bf16_f32 v52, v36, v37
    v_lshlrev_b32 v36, 16, v52
    v_and_b32 v37, 0xffff0000, v52
    v_pk_mul_f32 v[36:37], v[36:37], v[58:59]
    v_cvt_pk_bf16_f32 v40, v28, v29
    buffer_store_dword v40, v3, s[36:39], 0 offen offset:0
    v_cvt_pk_bf16_f32 v41, v30, v31
    buffer_store_dword v41, v3, s[36:39], 0 offen offset:256
    v_cvt_pk_bf16_f32 v42, v32, v33
    buffer_store_dword v42, v3, s[36:39], 0 offen offset:512
    v_cvt_pk_bf16_f32 v43, v34, v35
    buffer_store_dword v43, v3, s[36:39], 0 offen offset:768
    v_cvt_pk_bf16_f32 v44, v36, v37
    buffer_store_dword v44, v3, s[36:39], 0 offen offset:1024
rowb_kernel_done:
    s_endpgm
.globl lnz_kernel
.p2align 8
.type lnz_kernel,@function
lnz_kernel:
    s_cmp_ge_u32 s2, 256
    s_cbranch_scc1 lnz_done
    s_load_dwordx2 s[14:15], s[0:1], 104
    v_lshrrev_b32 v1, 6, v0
    v_and_b32 v2, 63, v0
    s_lshl_b32 s17, s2, 3
    v_add_u32 v3, s17, v1
    v_mul_u32_u24 v3, 3456, v3
    v_lshl_add_u32 v3, v2, 2, v3
    v_cmp_gt_u32 s[58:59], 48, v2
    v_add_u32 v4, 3264, v3
    s_nop 0
    v_cndmask_b32 v4, -1, v4, s[58:59]
    s_waitcnt lgkmcnt(0)
    s_add_u32 s24, s14, 24117248
    s_addc_u32 s25, s15, 0
    s_mov_b32 s26, 7077888
    s_mov_b32 s27, 0x00020000
    s_add_u32 s28, s14, 31457280
    s_addc_u32 s29, s15, 0
    s_mov_b32 s30, 3670016
    s_mov_b32 s31, 0x00020000
    buffer_load_dword v8, v3, s[24:27], 0 offen offset:1728
    buffer_load_dword v9, v3, s[24:27], 0 offen offset:1984
    buffer_load_dword v10, v3, s[24:27], 0 offen offset:2240
    buffer_load_dword v11, v3, s[24:27], 0 offen offset:2496
    buffer_load_dword v12, v3, s[24:27], 0 offen offset:2752
    buffer_load_dword v13, v3, s[24:27], 0 offen offset:3008
    buffer_load_dword v14, v4, s[24:27], 0 offen
    v_lshlrev_b32 v4, 5, v2
    v_lshl_add_u32 v4, v1, 1, v4
    s_waitcnt vmcnt(0)
    v_lshlrev_b32 v16, 16, v8
    v_and_b32 v17, 0xffff0000, v8
    v_lshlrev_b32 v18, 16, v9
    v_and_b32 v19, 0xffff0000, v9
    v_lshlrev_b32 v20, 16, v10
    v_and_b32 v21, 0xffff0000, v10
    v_lshlrev_b32 v22, 16, v11
    v_and_b32 v23, 0xffff0000, v11
    v_lshlrev_b32 v24, 16, v12
    v_and_b32 v25, 0xffff0000, v12
    v_lshlrev_b32 v26, 16, v13
    v_and_b32 v27, 0xffff0000, v13
    v_lshlrev_b32 v28, 16, v14
    v_and_b32 v29, 0xffff0000, v14
    v_pk_add_f32 v[52:53], v[16:17], v[18:19]
    v_pk_add_f32 v[52:53], v[52:53], v[20:21]
    v_pk_add_f32 v[52:53], v[52:53], v[22:23]
    v_pk_add_f32 v[52:53], v[52:53], v[24:25]
    v_pk_add_f32 v[52:53], v[52:53], v[26:27]
    v_pk_add_f32 v[52:53], v[52:53], v[28:29]
    v_add_f32 v52, v52, v53
    s_nop 1
    v_add_f32_dpp v53, v52, v52 quad_perm:[1,0,3,2] row_mask:0xf bank_mask:0xf
    s_nop 1
    v_add_f32_dpp v52, v53, v53 quad_perm:[2,3,0,1] row_mask:0xf bank_mask:0xf
    s_nop 1
    v_add_f32_dpp v53, v52, v52 row_half_mirror row_mask:0xf bank_mask:0xf
    s_nop 1
    v_add_f32_dpp v52, v53, v53 row_mirror row_mask:0xf bank_mask:0xf
    s_nop 0
    v_readlane_b32 s52, v52, 16
    v_readlane_b32 s53, v52, 32
    v_readlane_b32 s54, v52, 48
    s_nop 1
    v_add_f32 v52, s52, v52
    v_add_f32 v52, s53, v52
    v_add_f32 v52, s54, v52
    s_nop 0
    v_readlane_b32 s50, v52, 0
    s_nop 1
    v_mov_b32 v52, 0.0011574074074074073
    v_mul_f32 v54, s50, v52
    v_mul_f32 v55, s50, v52
    v_mov_b32 v56, 0
    v_mov_b32 v57, 0
    v_pk_add_f32 v[52:53], v[16:17], v[54:55] neg_lo:[0,1] neg_hi:[0,1]
    v_pk_fma_f32 v[56:57], v[52:53], v[52:53], v[56:57]
    v_pk_add_f32 v[52:53], v[18:19], v[54:55] neg_lo:[0,1] neg_hi:[0,1]
    v_pk_fma_f32 v[56:57], v[52:53], v[52:53], v[56:57]
    v_pk_add_f32 v[52:53], v[20:21], v[54:55] neg_lo:[0,1] neg_hi:[0,1]
    v_pk_fma_f32 v[56:57], v[52:53], v[52:53], v[56:57]
    v_pk_add_f32 v[52:53], v[22:23], v[54:55] neg_lo:[0,1] neg_hi:[0,1]
    v_pk_fma_f32 v[56:57], v[52:53], v[52:53], v[56:57]
    v_pk_add_f32 v[52:53], v[24:25], v[54:55] neg_lo:[0,1] neg_hi:[0,1]
    v_pk_fma_f32 v[56:57], v[52:53], v[52:53], v[56:57]
    v_pk_add_f32 v[52:53], v[26:27], v[54:55] neg_lo:[0,1] neg_hi:[0,1]
    v_pk_fma_f32 v[56:57], v[52:53], v[52:53], v[56:57]
    v_pk_add_f32 v[52:53], v[28:29], v[54:55] neg_lo:[0,1] neg_hi:[0,1]
    v_cndmask_b32 v52, 0, v52, s[58:59]
    v_cndmask_b32 v53, 0, v53, s[58:59]
    v_pk_fma_f32 v[56:57], v[52:53], v[52:53], v[56:57]
    v_add_f32 v52, v56, v57
    s_nop 1
    v_add_f32_dpp v53, v52, v52 quad_perm:[1,0,3,2] row_mask:0xf bank_mask:0xf
    s_nop 1
    v_add_f32_dpp v52, v53, v53 quad_perm:[2,3,0,1] row_mask:0xf bank_mask:0xf
    s_nop 1
    v_add_f32_dpp v53, v52, v52 row_half_mirror row_mask:0xf bank_mask:0xf
    s_nop 1
    v_add_f32_dpp v52, v53, v53 row_mirror row_mask:0xf bank_mask:0xf
    s_nop 0
    v_readlane_b32 s52, v52, 16
    v_readlane_b32 s53, v52, 32
    v_readlane_b32 s54, v52, 48
    s_nop 1
    v_add_f32 v52, s52, v52
    v_add_f32 v52, s53, v52
    v_add_f32 v52, s54, v52
    s_nop 0
    v_readlane_b32 s51, v52, 0
    s_nop 1
    v_mov_b32 v52, 0.0011574074074074073
    v_mul_f32 v56, s51, v52
    v_cvt_pk_bf16_f32 v52, v54, v56
    v_lshlrev_b32 v54, 16, v52
    v_and_b32 v56, 0xffff0000, v52
    v_mov_b32 v55, v54
    v_add_f32 v56, 0x3727c5ac, v56
    v_cvt_pk_bf16_f32 v52, v56, v56
    v_lshlrev_b32 v56, 16, v52
    v_sqrt_f32 v56, v56
    s_nop 0
    v_cvt_pk_bf16_f32 v52, v56, v56
    v_lshlrev_b32 v56, 16, v52
    v_rcp_f32 v58, v56
    s_nop 0
    v_fma_f32 v52, -v56, v58, 2.0
    v_mul_f32 v58, v58, v52
    v_mov_b32 v59, v58
    v_pk_add_f32 v[32:33], v[16:17], v[54:55] neg_lo:[0,1] neg_hi:[0,1]
    v_cvt_pk_bf16_f32 v52, v32, v33
    v_lshlrev_b32 v32, 16, v52
    v_and_b32 v33, 0xffff0000, v52
    v_pk_mul_f32 v[32:33], v[32:33], v[58:59]
    v_pk_add_f32 v[34:35], v[18:19], v[54:55] neg_lo:[0,1] neg_hi:[0,1]
    v_cvt_pk_bf16_f32 v52, v34, v35
    v_lshlrev_b32 v34, 16, v52
    v_and_b32 v35, 0xffff0000, v52
    v_pk_mul_f32 v[34:35], v[34:35], v[58:59]
    v_pk_add_f32 v[36:37], v[20:21], v[54:55] neg_lo:[0,1] neg_hi:[0,1]
    v_cvt_pk_bf16_f32 v52, v36, v37
    v_lshlrev_b32 v36, 16, v52
    v_and_b32 v37, 0xffff0000, v52
    v_pk_mul_f32 v[36:37], v[36:37], v[58:59]
    v_pk_add_f32 v[38:39], v[22:23], v[54:55] neg_lo:[0,1] neg_hi:[0,1]
    v_cvt_pk_bf16_f32 v52, v38, v39
    v_lshlrev_b32 v38, 16, v52
    v_and_b32 v39, 0xffff0000, v52
    v_pk_mul_f32 v[38:39], v[38:39], v[58:59]
    v_pk_add_f32 v[40:41], v[24:25], v[54:55] neg_lo:[0,1] neg_hi:[0,1]
    v_cvt_pk_bf16_f32 v52, v40, v41
    v_lshlrev_b32 v40, 16, v52
    v_and_b32 v41, 0xffff0000, v52
    v_pk_mul_f32 v[40:41], v[40:41], v[58:59]
    v_pk_add_f32 v[42:43], v[26:27], v[54:55] neg_lo:[0,1] neg_hi:[0,1]
    v_cvt_pk_bf16_f32 v52, v42, v43
    v_lshlrev_b32 v42, 16, v52
    v_and_b32 v43, 0xffff0000, v52
    v_pk_mul_f32 v[42:43], v[42:43], v[58:59]
    v_pk_add_f32 v[44:45], v[28:29], v[54:55] neg_lo:[0,1] neg_hi:[0,1]
    v_cvt_pk_bf16_f32 v52, v44, v45
    v_lshlrev_b32 v44, 16, v52
    v_and_b32 v45, 0xffff0000, v52
    v_pk_mul_f32 v[44:45], v[44:45], v[58:59]
    v_cvt_pk_bf16_f32 v8, v32, v33
    ds_write_b16 v4, v8 offset:0
    ds_write_b16_d16_hi v4, v8 offset:16
    v_cvt_pk_bf16_f32 v9, v34, v35
    ds_write_b16 v4, v9 offset:2048
    ds_write_b16_d16_hi v4, v9 offset:2064
    v_cvt_pk_bf16_f32 v10, v36, v37
    ds_write_b16 v4, v10 offset:4096
    ds_write_b16_d16_hi v4, v10 offset:4112
    v_cvt_pk_bf16_f32 v11, v38, v39
    ds_write_b16 v4, v11 offset:6144
    ds_write_b16_d16_hi v4, v11 offset:6160
    v_cvt_pk_bf16_f32 v12, v40, v41
    ds_write_b16 v4, v12 offset:8192
    ds_write_b16_d16_hi v4, v12 offset:8208
    v_cvt_pk_bf16_f32 v13, v42, v43
    ds_write_b16 v4, v13 offset:10240
    ds_write_b16_d16_hi v4, v13 offset:10256
    v_cvt_pk_bf16_f32 v14, v44, v45
    v_cndmask_b32 v14, 0, v14, s[58:59]
    ds_write_b16 v4, v14 offset:12288
    ds_write_b16_d16_hi v4, v14 offset:12304
    s_waitcnt lgkmcnt(0)
    s_barrier
    v_lshlrev_b32 v4, 4, v0
    ds_read_b128 v[8:11], v4
    ds_read_b128 v[12:15], v4 offset:8192
    s_mul_i32 s16, s2, 14336
    v_add_u32 v3, s16, v4
    v_cmp_gt_u32 vcc, 384, v0
    v_add_u32 v5, 8192, v3
    s_nop 0
    v_cndmask_b32 v5, -1, v5, vcc
    s_waitcnt lgkmcnt(0)
    buffer_store_dwordx4 v[8:11], v3, s[28:31], 0 offen
    buffer_store_dwordx4 v[12:15], v5, s[28:31], 0 offen
lnz_done:
    s_endpgm
.globl gemm1_kernel
.p2align 8
.type gemm1_kernel,@function
gemm1_kernel:
    s_cmp_ge_u32 s2, 224
    s_cbranch_scc1 gemm1_kernel_done
    s_load_dwordx2 s[4:5], s[0:1], 104
    s_load_dwordx2 s[6:7], s[0:1], 104
    s_load_dwordx2 s[14:15], s[0:1], 104
    s_load_dwordx2 s[10:11], s[0:1], 72
    s_load_dwordx2 s[12:13], s[0:1], 88
    s_and_b32 s16, s2, 15
    s_lshr_b32 s17, s2, 4
    s_mul_i32 s18, s16, 128
    s_mul_i32 s19, s17, 128
    v_lshrrev_b32 v1, 6, v0
    v_lshlrev_b32 v1, 10, v1
    s_nop 0
    v_readfirstlane_b32 s22, v1
    s_waitcnt lgkmcnt(0)
    s_add_u32 s24, s4, 20971520
    s_addc_u32 s25, s5, 0
    s_mov_b32 s26, 2621440
    s_mov_b32 s27, 0x00020000
    s_add_u32 s28, s6, 6291456
    s_addc_u32 s29, s7, 0
    s_mov_b32 s30, 2211840
    s_mov_b32 s31, 0x00020000
    v_lshrrev_b32 v1, 3, v0
    v_and_b32 v2, 7, v0
    v_lshrrev_b32 v3, 1, v1
    v_and_b32 v3, 7, v3
    v_xor_b32 v2, v2, v3
    v_lshlrev_b32 v2, 4, v2
    v_add_u32 v3, s18, v1
    v_mul_u32_u24 v3, 1280, v3
    v_add_u32 v4, v3, v2
    v_add_u32 v3, s19, v1
    v_mul_u32_u24 v3, 1280, v3
    v_mul_u32_u24 v9, 1, v2
    v_add_u32 v8, v3, v9
    v_add_u32 v5, 81920, v4
    v_add_u32 v9, 81920, v8
    v_lshrrev_b32 v1, 6, v0
    v_and_b32 v2, 63, v0
    v_and_b32 v3, 31, v2
    v_lshrrev_b32 v20, 5, v2
    v_and_b32 v21, 1, v1
    v_lshrrev_b32 v22, 1, v1
    v_mul_u32_u24 v23, 64, v21
    v_add_u32 v23, v23, v3
    v_lshrrev_b32 v12, 1, v23
    v_and_b32 v12, 7, v12
    v_xor_b32 v12, v12, v20
    v_mul_u32_u24 v23, 128, v23
    v_xor_b32 v15, 6, v12
    v_lshl_add_u32 v15, v15, 4, v23
    v_xor_b32 v14, 4, v12
    v_lshl_add_u32 v14, v14, 4, v23
    v_xor_b32 v13, 2, v12
    v_lshl_add_u32 v13, v13, 4, v23
    v_xor_b32 v12, 0, v12
    v_lshl_add_u32 v12, v12, 4, v23
    v_mul_u32_u24 v23, 32, v22
    v_add_u32 v23, v23, v3
    v_lshrrev_b32 v16, 1, v23
    v_and_b32 v16, 7, v16
    v_xor_b32 v16, v16, v20
    v_mul_u32_u24 v23, 128, v23
    v_add_u32 v23, 16384, v23
    v_xor_b32 v19, 6, v16
    v_lshl_add_u32 v19, v19, 4, v23
    v_xor_b32 v18, 4, v16
    v_lshl_add_u32 v18, v18, 4, v23
    v_xor_b32 v17, 2, v16
    v_lshl_add_u32 v17, v17, 4, v23
    v_xor_b32 v16, 0, v16
    v_lshl_add_u32 v16, v16, 4, v23
    v_mov_b32 v64, 0
    v_mov_b32 v65, 0
    v_mov_b32 v66, 0
    v_mov_b32 v67, 0
    v_mov_b32 v68, 0
    v_mov_b32 v69, 0
    v_mov_b32 v70, 0
    v_mov_b32 v71, 0
    v_mov_b32 v72, 0
    v_mov_b32 v73, 0
    v_mov_b32 v74, 0
    v_mov_b32 v75, 0
    v_mov_b32 v76, 0
    v_mov_b32 v77, 0
    v_mov_b32 v78, 0
    v_mov_b32 v79, 0
    v_mov_b32 v80, 0
    v_mov_b32 v81, 0
    v_mov_b32 v82, 0
    v_mov_b32 v83, 0
    v_mov_b32 v84, 0
    v_mov_b32 v85, 0
    v_mov_b32 v86, 0
    v_mov_b32 v87, 0
    v_mov_b32 v88, 0
    v_mov_b32 v89, 0
    v_mov_b32 v90, 0
    v_mov_b32 v91, 0
    v_mov_b32 v92, 0
    v_mov_b32 v93, 0
    v_mov_b32 v94, 0
    v_mov_b32 v95, 0
    v_mul_u32_u24 v23, 64, v21
    v_add_u32 v23, v23, v3
    v_add_u32 v96, s18, v23
    v_mul_u32_u24 v23, 32, v22
    v_lshlrev_b32 v97, 2, v20
    v_add_u32 v23, v23, v97
    v_add_u32 v97, s19, v23
    s_mov_b32 s20, 0
    s_mov_b32 s21, 0
    s_mov_b32 s55, s22
    s_mov_b32 s48, 0
    s_mov_b32 s49, 0
gp_1:
    s_add_u32 m0, s55, 0
    s_nop 0
    buffer_load_dwordx4 v4, s[24:27], s20 offen lds
    s_add_u32 m0, s55, 8192
    s_nop 0
    buffer_load_dwordx4 v5, s[24:27], s20 offen lds
    s_add_u32 m0, s55, 16384
    s_nop 0
    buffer_load_dwordx4 v8, s[28:31], s21 offen lds
    s_add_u32 m0, s55, 24576
    s_nop 0
    buffer_load_dwordx4 v9, s[28:31], s21 offen lds
    s_add_u32 s20, s20, 128
    s_add_u32 s21, s21, 128
    s_add_u32 s55, s55, 32768
    s_cmp_lt_u32 s55, 131072
    s_cselect_b32 s55, s55, s22
    s_add_u32 s48, s48, 1
    s_cmp_lt_u32 s48, 3
    s_cbranch_scc1 gp_1
    s_mov_b32 s48, 0
gm_2:
    s_cmp_lt_u32 s48, 8
    s_cbranch_scc1 gw_3
    s_waitcnt vmcnt(0)
gw_3:
    s_waitcnt vmcnt(8)
    s_barrier
    v_add_u32 v24, s49, v12
    v_add_u32 v25, s49, v13
    v_add_u32 v26, s49, v14
    v_add_u32 v27, s49, v15
    v_add_u32 v28, s49, v16
    v_add_u32 v29, s49, v17
    v_add_u32 v30, s49, v18
    v_add_u32 v31, s49, v19
    ds_read_b128 v[32:35], v24 offset:0
    ds_read_b128 v[36:39], v24 offset:4096
    ds_read_b128 v[48:51], v28 offset:0
    s_cmp_lt_u32 s48, 7
    s_cbranch_scc0 gn_4
    ds_read_b128 v[40:43], v25 offset:0
    ds_read_b128 v[44:47], v25 offset:4096
    ds_read_b128 v[52:55], v29 offset:0
    s_waitcnt lgkmcnt(3)
    v_mfma_f32_32x32x16_bf16 v[64:79], v[48:51], v[32:35], v[64:79]
    s_add_u32 m0, s55, 0
    s_nop 0
    buffer_load_dwordx4 v4, s[24:27], s20 offen lds
    v_mfma_f32_32x32x16_bf16 v[80:95], v[48:51], v[36:39], v[80:95]
    ds_read_b128 v[32:35], v26 offset:0
    ds_read_b128 v[36:39], v26 offset:4096
    ds_read_b128 v[48:51], v30 offset:0
    s_waitcnt lgkmcnt(3)
    v_mfma_f32_32x32x16_bf16 v[64:79], v[52:55], v[40:43], v[64:79]
    s_add_u32 m0, s55, 8192
    s_nop 0
    buffer_load_dwordx4 v5, s[24:27], s20 offen lds
    v_mfma_f32_32x32x16_bf16 v[80:95], v[52:55], v[44:47], v[80:95]
    ds_read_b128 v[40:43], v27 offset:0
    ds_read_b128 v[44:47], v27 offset:4096
    ds_read_b128 v[52:55], v31 offset:0
    s_waitcnt lgkmcnt(3)
    v_mfma_f32_32x32x16_bf16 v[64:79], v[48:51], v[32:35], v[64:79]
    s_add_u32 m0, s55, 16384
    s_nop 0
    buffer_load_dwordx4 v8, s[28:31], s21 offen lds
    v_mfma_f32_32x32x16_bf16 v[80:95], v[48:51], v[36:39], v[80:95]
    s_waitcnt lgkmcnt(0)
    v_mfma_f32_32x32x16_bf16 v[64:79], v[52:55], v[40:43], v[64:79]
    s_add_u32 m0, s55, 24576
    s_nop 0
    buffer_load_dwordx4 v9, s[28:31], s21 offen lds
    v_mfma_f32_32x32x16_bf16 v[80:95], v[52:55], v[44:47], v[80:95]
    s_add_u32 s20, s20, 128
    s_add_u32 s21, s21, 128
    s_add_u32 s55, s55, 32768
    s_cmp_lt_u32 s55, 131072
    s_cselect_b32 s55, s55, s22
    s_branch gx_5
gn_4:
    ds_read_b128 v[40:43], v25 offset:0
    ds_read_b128 v[44:47], v25 offset:4096
    ds_read_b128 v[52:55], v29 offset:0
    s_waitcnt lgkmcnt(3)
    v_mfma_f32_32x32x16_bf16 v[64:79], v[48:51], v[32:35], v[64:79]
    v_mfma_f32_32x32x16_bf16 v[80:95], v[48:51], v[36:39], v[80:95]
    ds_read_b128 v[32:35], v26 offset:0
    ds_read_b128 v[36:39], v26 offset:4096
    ds_read_b128 v[48:51], v30 offset:0
    s_waitcnt lgkmcnt(3)
    v_mfma_f32_32x32x16_bf16 v[64:79], v[52:55], v[40:43], v[64:79]
    v_mfma_f32_32x32x16_bf16 v[80:95], v[52:55], v[44:47], v[80:95]
    ds_read_b128 v[40:43], v27 offset:0
    ds_read_b128 v[44:47], v27 offset:4096
    ds_read_b128 v[52:55], v31 offset:0
    s_waitcnt lgkmcnt(3)
    v_mfma_f32_32x32x16_bf16 v[64:79], v[48:51], v[32:35], v[64:79]
    v_mfma_f32_32x32x16_bf16 v[80:95], v[48:51], v[36:39], v[80:95]
    s_waitcnt lgkmcnt(0)
    v_mfma_f32_32x32x16_bf16 v[64:79], v[52:55], v[40:43], v[64:79]
    v_mfma_f32_32x32x16_bf16 v[80:95], v[52:55], v[44:47], v[80:95]
gx_5:
    s_add_u32 s49, s49, 32768
    s_cmp_lt_u32 s49, 131072
    s_cselect_b32 s49, s49, 0
    s_add_u32 s48, s48, 1
    s_cmp_lt_u32 s48, 10
    s_cbranch_scc1 gm_2
    s_nop 7
    s_nop 7
    s_barrier
    s_add_u32 s32, s14, 24117248
    s_addc_u32 s33, s15, 0
    s_mov_b32 s34, 7077888
    s_mov_b32 s35, 0x00020000
    v_mov_b32 v48, 0x3dd2d3e8
    v_mov_b32 v49, 0x3dd2d3e8
    v_mov_b32 v50, 0x40135761
    v_mov_b32 v51, 0x40135761
    v_mov_b32 v52, 1.0
    v_mov_b32 v53, 1.0
    s_mov_b32 s48, 0
ge_6:
    s_lshl_b32 s56, s48, 2
    s_lshr_b32 s49, s48, 2
    s_lshl_b32 s49, s49, 5
    s_lshr_b32 s55, s48, 2
    s_and_b32 s55, s55, 0
    s_lshl_b32 s55, s55, 5
    s_and_b32 s20, s48, 3
    s_lshl_b32 s20, s20, 3
    s_add_u32 s55, s55, s20
    s_set_gpr_idx_on s56, gpr_idx(SRC0)
    v_mov_b32 v40, v64
    v_mov_b32 v41, v65
    v_mov_b32 v42, v66
    v_mov_b32 v43, v67
    s_set_gpr_idx_off
    v_add_u32 v4, s49, v96
    v_add_u32 v5, s55, v97
    v_cvt_pk_bf16_f32 v8, v40, v41
    v_lshlrev_b32 v40, 16, v8
    v_and_b32 v41, 0xffff0000, v8
    v_cvt_pk_bf16_f32 v9, v42, v43
    v_lshlrev_b32 v42, 16, v9
    v_and_b32 v43, 0xffff0000, v9
    v_pk_mul_f32 v[44:45], v[40:41], v[40:41]
    v_pk_mul_f32 v[46:47], v[42:43], v[42:43]
    v_pk_fma_f32 v[44:45], v[44:45], v[48:49], v[50:51]
    v_pk_fma_f32 v[46:47], v[46:47], v[48:49], v[50:51]
    v_pk_mul_f32 v[44:45], v[44:45], v[40:41]
    v_pk_mul_f32 v[46:47], v[46:47], v[42:43]
    v_exp_f32 v44, v44
    v_exp_f32 v45, v45
    v_exp_f32 v46, v46
    v_exp_f32 v47, v47
    v_pk_add_f32 v[44:45], v[44:45], v[52:53]
    v_pk_add_f32 v[46:47], v[46:47], v[52:53]
    v_rcp_f32 v44, v44
    v_rcp_f32 v45, v45
    v_rcp_f32 v46, v46
    v_rcp_f32 v47, v47
    v_subrev_u32 v6, s18, v4
    v_mul_u32_u24 v6, 272, v6
    v_subrev_u32 v7, s19, v5
    v_lshl_add_u32 v7, v7, 1, v6
    v_pk_fma_f32 v[40:41], v[40:41], v[44:45], v[40:41] neg_lo:[1,0,0] neg_hi:[1,0,0]
    v_pk_fma_f32 v[42:43], v[42:43], v[46:47], v[42:43] neg_lo:[1,0,0] neg_hi:[1,0,0]
    v_cvt_pk_bf16_f32 v10, v40, v41
    v_cvt_pk_bf16_f32 v11, v42, v43
    ds_write_b64 v7, v[10:11]
    s_add_u32 s48, s48, 1
    s_cmp_lt_u32 s48, 8
    s_cbranch_scc1 ge_6
    s_waitcnt lgkmcnt(0)
    s_barrier
    v_add_u32 v6, 0, v0
    v_lshrrev_b32 v4, 4, v6
    v_and_b32 v5, 15, v6
    v_lshlrev_b32 v5, 3, v5
    v_mul_u32_u24 v7, 272, v4
    v_lshl_add_u32 v7, v5, 1, v7
    v_add_u32 v4, s18, v4
    v_add_u32 v5, s19, v5
    ds_read_b128 v[32:35], v7
    v_mul_u32_u24 v6, 3456, v4
    v_cmp_gt_u32 vcc, 1728, v5
    v_lshl_add_u32 v6, v5, 1, v6
    s_nop 0
    v_cndmask_b32 v6, -1, v6, vcc
    s_waitcnt lgkmcnt(0)
    buffer_store_dwordx4 v[32:35], v6, s[32:35], 0 offen
    v_add_u32 v6, 512, v0
    v_lshrrev_b32 v4, 4, v6
    v_and_b32 v5, 15, v6
    v_lshlrev_b32 v5, 3, v5
    v_mul_u32_u24 v7, 272, v4
    v_lshl_add_u32 v7, v5, 1, v7
    v_add_u32 v4, s18, v4
    v_add_u32 v5, s19, v5
    ds_read_b128 v[36:39], v7
    v_mul_u32_u24 v6, 3456, v4
    v_cmp_gt_u32 vcc, 1728, v5
    v_lshl_add_u32 v6, v5, 1, v6
    s_nop 0
    v_cndmask_b32 v6, -1, v6, vcc
    s_waitcnt lgkmcnt(0)
    buffer_store_dwordx4 v[36:39], v6, s[32:35], 0 offen
    v_add_u32 v6, 1024, v0
    v_lshrrev_b32 v4, 4, v6
    v_and_b32 v5, 15, v6
    v_lshlrev_b32 v5, 3, v5
    v_mul_u32_u24 v7, 272, v4
    v_lshl_add_u32 v7, v5, 1, v7
    v_add_u32 v4, s18, v4
    v_add_u32 v5, s19, v5
    ds_read_b128 v[40:43], v7
    v_mul_u32_u24 v6, 3456, v4
    v_cmp_gt_u32 vcc, 1728, v5
    v_lshl_add_u32 v6, v5, 1, v6
    s_nop 0
    v_cndmask_b32 v6, -1, v6, vcc
    s_waitcnt lgkmcnt(0)
    buffer_store_dwordx4 v[40:43], v6, s[32:35], 0 offen
    v_add_u32 v6, 1536, v0
    v_lshrrev_b32 v4, 4, v6
    v_and_b32 v5, 15, v6
    v_lshlrev_b32 v5, 3, v5
    v_mul_u32_u24 v7, 272, v4
    v_lshl_add_u32 v7, v5, 1, v7
    v_add_u32 v4, s18, v4
    v_add_u32 v5, s19, v5
    ds_read_b128 v[44:47], v7
    v_mul_u32_u24 v6, 3456, v4
    v_cmp_gt_u32 vcc, 1728, v5
    v_lshl_add_u32 v6, v5, 1, v6
    s_nop 0
    v_cndmask_b32 v6, -1, v6, vcc
    s_waitcnt lgkmcnt(0)
    buffer_store_dwordx4 v[44:47], v6, s[32:35], 0 offen
    s_waitcnt vmcnt(0)
gemm1_kernel_done:
    s_endpgm
.globl gemm2_kernel
.p2align 8
.type gemm2_kernel,@function
gemm2_kernel:
    s_cmp_ge_u32 s2, 224
    s_cbranch_scc1 gemm2_kernel_done
    s_load_dwordx2 s[4:5], s[0:1], 64
    s_load_dwordx2 s[6:7], s[0:1], 104
    s_load_dwordx2 s[14:15], s[0:1], 104
    s_load_dwordx2 s[10:11], s[0:1], 72
    s_load_dwordx2 s[12:13], s[0:1], 88
    s_and_b32 s16, s2, 15
    s_lshr_b32 s17, s2, 4
    s_mul_i32 s18, s16, 128
    s_mul_i32 s19, s17, 64
    v_lshrrev_b32 v1, 6, v0
    v_lshlrev_b32 v1, 10, v1
    s_nop 0
    v_readfirstlane_b32 s22, v1
    s_waitcnt lgkmcnt(0)
    s_mov_b32 s24, s4
    s_mov_b32 s25, s5
    s_mov_b32 s26, 8388608
    s_mov_b32 s27, 0x00020000
    s_add_u32 s28, s6, 31457280
    s_addc_u32 s29, s7, 0
    s_mov_b32 s30, 3670016
    s_mov_b32 s31, 0x00020000
    v_lshrrev_b32 v1, 3, v0
    v_and_b32 v2, 7, v0
    v_lshrrev_b32 v3, 1, v1
    v_and_b32 v3, 7, v3
    v_xor_b32 v2, v2, v3
    v_lshlrev_b32 v2, 4, v2
    v_add_u32 v3, s18, v1
    v_mul_u32_u24 v3, 4096, v3
    v_add_u32 v4, v3, v2
    v_add_u32 v3, s19, v1
    v_mul_u32_u24 v3, 16, v3
    v_mul_u32_u24 v9, 896, v2
    v_add_u32 v8, v3, v9
    v_lshrrev_b32 v3, 6, v0
    v_mul_u32_u24 v3, 896, v3
    v_and_b32 v9, 63, v0
    v_add3_u32 v3, v3, v9, s19
    v_lshlrev_b32 v8, 4, v3
    v_add_u32 v5, 262144, v4
    v_lshrrev_b32 v1, 6, v0
    v_and_b32 v2, 63, v0
    v_and_b32 v3, 31, v2
    v_lshrrev_b32 v20, 5, v2
    v_and_b32 v21, 3, v1
    v_lshrrev_b32 v22, 2, v1
    v_mul_u32_u24 v23, 32, v21
    v_add_u32 v23, v23, v3
    v_lshrrev_b32 v12, 1, v23
    v_and_b32 v12, 7, v12
    v_xor_b32 v12, v12, v20
    v_mul_u32_u24 v23, 128, v23
    v_xor_b32 v15, 6, v12
    v_lshl_add_u32 v15, v15, 4, v23
    v_xor_b32 v14, 4, v12
    v_lshl_add_u32 v14, v14, 4, v23
    v_xor_b32 v13, 2, v12
    v_lshl_add_u32 v13, v13, 4, v23
    v_xor_b32 v12, 0, v12
    v_lshl_add_u32 v12, v12, 4, v23
    v_mul_u32_u24 v23, 32, v22
    v_add_u32 v23, v23, v3
    v_lshrrev_b32 v16, 1, v23
    v_and_b32 v16, 7, v16
    v_xor_b32 v16, v16, v20
    v_mul_u32_u24 v23, 128, v23
    v_add_u32 v23, 16384, v23
    v_xor_b32 v19, 6, v16
    v_lshl_add_u32 v19, v19, 4, v23
    v_xor_b32 v18, 4, v16
    v_lshl_add_u32 v18, v18, 4, v23
    v_xor_b32 v17, 2, v16
    v_lshl_add_u32 v17, v17, 4, v23
    v_xor_b32 v16, 0, v16
    v_lshl_add_u32 v16, v16, 4, v23
    v_mul_u32_u24 v23, 32, v22
    v_add_u32 v23, v23, v3
    v_lshl_add_u32 v23, v20, 6, v23
    v_lshlrev_b32 v23, 4, v23
    v_add_u32 v16, 16384, v23
    v_add_u32 v17, 18432, v23
    v_add_u32 v18, 20480, v23
    v_add_u32 v19, 22528, v23
    v_mov_b32 v64, 0
    v_mov_b32 v65, 0
    v_mov_b32 v66, 0
    v_mov_b32 v67, 0
    v_mov_b32 v68, 0
    v_mov_b32 v69, 0
    v_mov_b32 v70, 0
    v_mov_b32 v71, 0
    v_mov_b32 v72, 0
    v_mov_b32 v73, 0
    v_mov_b32 v74, 0
    v_mov_b32 v75, 0
    v_mov_b32 v76, 0
    v_mov_b32 v77, 0
    v_mov_b32 v78, 0
    v_mov_b32 v79, 0
    v_mul_u32_u24 v23, 32, v21
    v_add_u32 v23, v23, v3
    v_add_u32 v80, s18, v23
    v_mul_u32_u24 v23, 32, v22
    v_lshlrev_b32 v81, 2, v20
    v_add_u32 v23, v23, v81
    v_add_u32 v81, s19, v23
    s_add_u32 s32, s14, 24117248
    s_addc_u32 s33, s15, 0
    s_mov_b32 s34, 7077888
    s_mov_b32 s35, 0x00020000
    s_mov_b32 s44, s10
    s_mov_b32 s45, s11
    s_mov_b32 s46, 4096
    s_mov_b32 s47, 0x00020000
    v_add_u32 v23, 0, v80
    v_lshlrev_b32 v104, 1, v23
    buffer_load_ushort v100, v104, s[44:47], 0 offen
    v_add_u32 v42, 0, v0
    v_lshrrev_b32 v40, 3, v42
    v_and_b32 v41, 7, v42
    v_lshlrev_b32 v41, 3, v41
    v_mul_u32_u24 v43, 144, v40
    v_lshl_add_u32 v43, v41, 1, v43
    v_add_u32 v40, s18, v40
    v_add_u32 v41, s19, v41
    v_mul_u32_u24 v42, 3456, v40
    v_cmp_gt_u32 vcc, 864, v41
    v_lshl_add_u32 v42, v41, 1, v42
    s_nop 0
    v_cndmask_b32 v42, -1, v42, vcc
    buffer_load_dwordx4 v[84:87], v42, s[32:35], 0 offen
    v_add_u32 v42, 512, v0
    v_lshrrev_b32 v40, 3, v42
    v_and_b32 v41, 7, v42
    v_lshlrev_b32 v41, 3, v41
    v_mul_u32_u24 v43, 144, v40
    v_lshl_add_u32 v43, v41, 1, v43
    v_add_u32 v40, s18, v40
    v_add_u32 v41, s19, v41
    v_mul_u32_u24 v42, 3456, v40
    v_cmp_gt_u32 vcc, 864, v41
    v_lshl_add_u32 v42, v41, 1, v42
    s_nop 0
    v_cndmask_b32 v42, -1, v42, vcc
    buffer_load_dwordx4 v[88:91], v42, s[32:35], 0 offen
    s_mov_b32 s20, 0
    s_mov_b32 s21, 0
    s_mov_b32 s55, s22
    s_mov_b32 s48, 0
    s_mov_b32 s49, 0
gp_7:
    s_add_u32 m0, s55, 0
    s_nop 0
    buffer_load_dwordx4 v4, s[24:27], s20 offen lds
    s_add_u32 m0, s55, 8192
    s_nop 0
    buffer_load_dwordx4 v5, s[24:27], s20 offen lds
    s_add_u32 m0, s55, 16384
    s_nop 0
    buffer_load_dwordx4 v8, s[28:31], s21 offen lds
    s_add_u32 s20, s20, 128
    s_add_u32 s21, s21, 114688
    s_add_u32 s55, s55, 24576
    s_cmp_lt_u32 s55, 98304
    s_cselect_b32 s55, s55, s22
    s_add_u32 s48, s48, 1
    s_cmp_lt_u32 s48, 3
    s_cbranch_scc1 gp_7
    s_mov_b32 s48, 0
gm_8:
    s_cmp_lt_u32 s48, 30
    s_cbranch_scc1 gw_9
    s_waitcnt vmcnt(0)
gw_9:
    s_waitcnt vmcnt(6)
    s_barrier
    v_add_u32 v24, s49, v12
    v_add_u32 v25, s49, v13
    v_add_u32 v26, s49, v14
    v_add_u32 v27, s49, v15
    v_add_u32 v28, s49, v16
    v_add_u32 v29, s49, v17
    v_add_u32 v30, s49, v18
    v_add_u32 v31, s49, v19
    ds_read_b128 v[32:35], v24 offset:0
    ds_read_b128 v[40:43], v28 offset:0
    s_cmp_lt_u32 s48, 29
    s_cbranch_scc0 gn_10
    ds_read_b128 v[36:39], v25 offset:0
    ds_read_b128 v[44:47], v29 offset:0
    s_waitcnt lgkmcnt(2)
    v_mfma_f32_32x32x16_bf16 v[64:79], v[40:43], v[32:35], v[64:79]
    s_add_u32 m0, s55, 0
    s_nop 0
    buffer_load_dwordx4 v4, s[24:27], s20 offen lds
    ds_read_b128 v[32:35], v26 offset:0
    ds_read_b128 v[40:43], v30 offset:0
    s_waitcnt lgkmcnt(2)
    v_mfma_f32_32x32x16_bf16 v[64:79], v[44:47], v[36:39], v[64:79]
    s_add_u32 m0, s55, 8192
    s_nop 0
    buffer_load_dwordx4 v5, s[24:27], s20 offen lds
    ds_read_b128 v[36:39], v27 offset:0
    ds_read_b128 v[44:47], v31 offset:0
    s_waitcnt lgkmcnt(2)
    v_mfma_f32_32x32x16_bf16 v[64:79], v[40:43], v[32:35], v[64:79]
    s_add_u32 m0, s55, 16384
    s_nop 0
    buffer_load_dwordx4 v8, s[28:31], s21 offen lds
    s_waitcnt lgkmcnt(0)
    v_mfma_f32_32x32x16_bf16 v[64:79], v[44:47], v[36:39], v[64:79]
    s_add_u32 s20, s20, 128
    s_add_u32 s21, s21, 114688
    s_add_u32 s55, s55, 24576
    s_cmp_lt_u32 s55, 98304
    s_cselect_b32 s55, s55, s22
    s_branch gx_11
gn_10:
    ds_read_b128 v[36:39], v25 offset:0
    ds_read_b128 v[44:47], v29 offset:0
    s_waitcnt lgkmcnt(2)
    v_mfma_f32_32x32x16_bf16 v[64:79], v[40:43], v[32:35], v[64:79]
    ds_read_b128 v[32:35], v26 offset:0
    ds_read_b128 v[40:43], v30 offset:0
    s_waitcnt lgkmcnt(2)
    v_mfma_f32_32x32x16_bf16 v[64:79], v[44:47], v[36:39], v[64:79]
    ds_read_b128 v[36:39], v27 offset:0
    ds_read_b128 v[44:47], v31 offset:0
    s_waitcnt lgkmcnt(2)
    v_mfma_f32_32x32x16_bf16 v[64:79], v[40:43], v[32:35], v[64:79]
    s_waitcnt lgkmcnt(0)
    v_mfma_f32_32x32x16_bf16 v[64:79], v[44:47], v[36:39], v[64:79]
gx_11:
    s_add_u32 s49, s49, 24576
    s_cmp_lt_u32 s49, 98304
    s_cselect_b32 s49, s49, 0
    s_add_u32 s48, s48, 1
    s_cmp_lt_u32 s48, 32
    s_cbranch_scc1 gm_8
    s_nop 7
    s_nop 7
    s_barrier
    s_add_u32 s36, s14, 35651584
    s_addc_u32 s37, s15, 0
    s_mov_b32 s38, 3670016
    s_mov_b32 s39, 0x00020000
    v_lshlrev_b32 v100, 16, v100
    s_mov_b32 s48, 0
ge_12:
    s_lshl_b32 s56, s48, 2
    s_lshr_b32 s49, s48, 2
    s_lshl_b32 s49, s49, 5
    s_lshr_b32 s55, s48, 2
    s_and_b32 s55, s55, 0
    s_lshl_b32 s55, s55, 5
    s_and_b32 s20, s48, 3
    s_lshl_b32 s20, s20, 3
    s_add_u32 s55, s55, s20
    s_set_gpr_idx_on s56, gpr_idx(SRC0)
    v_mov_b32 v40, v64
    v_mov_b32 v41, v65
    v_mov_b32 v42, v66
    v_mov_b32 v43, v67
    s_set_gpr_idx_off
    v_add_u32 v4, s49, v80
    v_add_u32 v5, s55, v81
    s_lshr_b32 s56, s48, 2
    s_set_gpr_idx_on s56, gpr_idx(SRC0)
    v_mov_b32 v12, v100
    s_set_gpr_idx_off
    v_subrev_u32 v6, s18, v4
    v_mul_u32_u24 v6, 144, v6
    v_subrev_u32 v7, s19, v5
    v_lshl_add_u32 v7, v7, 1, v6
    v_cvt_pk_bf16_f32 v8, v40, v41
    v_lshlrev_b32 v40, 16, v8
    v_and_b32 v41, 0xffff0000, v8
    v_cvt_pk_bf16_f32 v9, v42, v43
    v_lshlrev_b32 v42, 16, v9
    v_and_b32 v43, 0xffff0000, v9
    v_add_f32 v40, v40, v12
    v_add_f32 v41, v41, v12
    v_add_f32 v42, v42, v12
    v_add_f32 v43, v43, v12
    v_cvt_pk_bf16_f32 v10, v40, v41
    v_cvt_pk_bf16_f32 v11, v42, v43
    ds_write_b64 v7, v[10:11]
    s_add_u32 s48, s48, 1
    s_cmp_lt_u32 s48, 4
    s_cbranch_scc1 ge_12
    s_waitcnt lgkmcnt(0)
    s_barrier
    v_add_u32 v6, 0, v0
    v_lshrrev_b32 v4, 3, v6
    v_and_b32 v5, 7, v6
    v_lshlrev_b32 v5, 3, v5
    v_mul_u32_u24 v7, 144, v4
    v_lshl_add_u32 v7, v5, 1, v7
    v_add_u32 v4, s18, v4
    v_add_u32 v5, s19, v5
    ds_read_b128 v[32:35], v7
    v_mul_u32_u24 v6, 1792, v4
    v_lshl_add_u32 v6, v5, 1, v6
    s_waitcnt lgkmcnt(0)
    v_lshlrev_b32 v36, 16, v32
    v_and_b32 v37, 0xffff0000, v32
    v_lshlrev_b32 v38, 16, v84
    v_and_b32 v39, 0xffff0000, v84
    v_mul_f32 v36, v36, v38
    v_mul_f32 v37, v37, v39
    v_cvt_pk_bf16_f32 v84, v36, v37
    v_lshlrev_b32 v36, 16, v33
    v_and_b32 v37, 0xffff0000, v33
    v_lshlrev_b32 v38, 16, v85
    v_and_b32 v39, 0xffff0000, v85
    v_mul_f32 v36, v36, v38
    v_mul_f32 v37, v37, v39
    v_cvt_pk_bf16_f32 v85, v36, v37
    v_lshlrev_b32 v36, 16, v34
    v_and_b32 v37, 0xffff0000, v34
    v_lshlrev_b32 v38, 16, v86
    v_and_b32 v39, 0xffff0000, v86
    v_mul_f32 v36, v36, v38
    v_mul_f32 v37, v37, v39
    v_cvt_pk_bf16_f32 v86, v36, v37
    v_lshlrev_b32 v36, 16, v35
    v_and_b32 v37, 0xffff0000, v35
    v_lshlrev_b32 v38, 16, v87
    v_and_b32 v39, 0xffff0000, v87
    v_mul_f32 v36, v36, v38
    v_mul_f32 v37, v37, v39
    v_cvt_pk_bf16_f32 v87, v36, v37
    buffer_store_dwordx4 v[84:87], v6, s[36:39], 0 offen
    v_add_u32 v6, 512, v0
    v_lshrrev_b32 v4, 3, v6
    v_and_b32 v5, 7, v6
    v_lshlrev_b32 v5, 3, v5
    v_mul_u32_u24 v7, 144, v4
    v_lshl_add_u32 v7, v5, 1, v7
    v_add_u32 v4, s18, v4
    v_add_u32 v5, s19, v5
    ds_read_b128 v[32:35], v7
    v_mul_u32_u24 v6, 1792, v4
    v_lshl_add_u32 v6, v5, 1, v6
    s_waitcnt lgkmcnt(0)
    v_lshlrev_b32 v36, 16, v32
    v_and_b32 v37, 0xffff0000, v32
    v_lshlrev_b32 v38, 16, v88
    v_and_b32 v39, 0xffff0000, v88
    v_mul_f32 v36, v36, v38
    v_mul_f32 v37, v37, v39
    v_cvt_pk_bf16_f32 v88, v36, v37
    v_lshlrev_b32 v36, 16, v33
    v_and_b32 v37, 0xffff0000, v33
    v_lshlrev_b32 v38, 16, v89
    v_and_b32 v39, 0xffff0000, v89
    v_mul_f32 v36, v36, v38
    v_mul_f32 v37, v37, v39
    v_cvt_pk_bf16_f32 v89, v36, v37
    v_lshlrev_b32 v36, 16, v34
    v_and_b32 v37, 0xffff0000, v34
    v_lshlrev_b32 v38, 16, v90
    v_and_b32 v39, 0xffff0000, v90
    v_mul_f32 v36, v36, v38
    v_mul_f32 v37, v37, v39
    v_cvt_pk_bf16_f32 v90, v36, v37
    v_lshlrev_b32 v36, 16, v35
    v_and_b32 v37, 0xffff0000, v35
    v_lshlrev_b32 v38, 16, v91
    v_and_b32 v39, 0xffff0000, v91
    v_mul_f32 v36, v36, v38
    v_mul_f32 v37, v37, v39
    v_cvt_pk_bf16_f32 v91, v36, v37
    buffer_store_dwordx4 v[88:91], v6, s[36:39], 0 offen
    s_waitcnt vmcnt(0)
gemm2_kernel_done:
    s_endpgm
.globl gemm3a_kernel
.p2align 8
.type gemm3a_kernel,@function
gemm3a_kernel:
    s_cmp_ge_u32 s2, 160
    s_cbranch_scc1 gemm3a_kernel_done
    s_load_dwordx2 s[4:5], s[0:1], 104
    s_load_dwordx2 s[6:7], s[0:1], 104
    s_load_dwordx2 s[14:15], s[0:1], 104
    s_load_dwordx2 s[10:11], s[0:1], 72
    s_load_dwordx2 s[12:13], s[0:1], 88
    s_and_b32 s16, s2, 15
    s_lshr_b32 s17, s2, 4
    s_mul_i32 s18, s16, 128
    s_mul_i32 s19, s17, 64
    v_lshrrev_b32 v1, 6, v0
    v_lshlrev_b32 v1, 10, v1
    s_nop 0
    v_readfirstlane_b32 s22, v1
    s_waitcnt lgkmcnt(0)
    s_add_u32 s24, s4, 35651584
    s_addc_u32 s25, s5, 0
    s_mov_b32 s26, 3670016
    s_mov_b32 s27, 0x00020000
    s_add_u32 s28, s6, 9437184
    s_addc_u32 s29, s7, 0
    s_mov_b32 s30, 1146880
    s_mov_b32 s31, 0x00020000
    v_lshrrev_b32 v1, 3, v0
    v_and_b32 v2, 7, v0
    v_lshrrev_b32 v3, 1, v1
    v_and_b32 v3, 7, v3
    v_xor_b32 v2, v2, v3
    v_lshlrev_b32 v2, 4, v2
    v_add_u32 v3, s18, v1
    v_mul_u32_u24 v3, 1792, v3
    v_add_u32 v4, v3, v2
    v_add_u32 v3, s19, v1
    v_mul_u32_u24 v3, 1792, v3
    v_mul_u32_u24 v9, 1, v2
    v_add_u32 v8, v3, v9
    v_add_u32 v5, 114688, v4
    v_lshrrev_b32 v1, 6, v0
    v_and_b32 v2, 63, v0
    v_and_b32 v3, 31, v2
    v_lshrrev_b32 v20, 5, v2
    v_and_b32 v21, 3, v1
    v_lshrrev_b32 v22, 2, v1
    v_mul_u32_u24 v23, 32, v21
    v_add_u32 v23, v23, v3
    v_lshrrev_b32 v12, 1, v23
    v_and_b32 v12, 7, v12
    v_xor_b32 v12, v12, v20
    v_mul_u32_u24 v23, 128, v23
    v_xor_b32 v15, 6, v12
    v_lshl_add_u32 v15, v15, 4, v23
    v_xor_b32 v14, 4, v12
    v_lshl_add_u32 v14, v14, 4, v23
    v_xor_b32 v13, 2, v12
    v_lshl_add_u32 v13, v13, 4, v23
    v_xor_b32 v12, 0, v12
    v_lshl_add_u32 v12, v12, 4, v23
    v_mul_u32_u24 v23, 32, v22
    v_add_u32 v23, v23, v3
    v_lshrrev_b32 v16, 1, v23
    v_and_b32 v16, 7, v16
    v_xor_b32 v16, v16, v20
    v_mul_u32_u24 v23, 128, v23
    v_add_u32 v23, 16384, v23
    v_xor_b32 v19, 6, v16
    v_lshl_add_u32 v19, v19, 4, v23
    v_xor_b32 v18, 4, v16
    v_lshl_add_u32 v18, v18, 4, v23
    v_xor_b32 v17, 2, v16
    v_lshl_add_u32 v17, v17, 4, v23
    v_xor_b32 v16, 0, v16
    v_lshl_add_u32 v16, v16, 4, v23
    v_mov_b32 v64, 0
    v_mov_b32 v65, 0
    v_mov_b32 v66, 0
    v_mov_b32 v67, 0
    v_mov_b32 v68, 0
    v_mov_b32 v69, 0
    v_mov_b32 v70, 0
    v_mov_b32 v71, 0
    v_mov_b32 v72, 0
    v_mov_b32 v73, 0
    v_mov_b32 v74, 0
    v_mov_b32 v75, 0
    v_mov_b32 v76, 0
    v_mov_b32 v77, 0
    v_mov_b32 v78, 0
    v_mov_b32 v79, 0
    v_mul_u32_u24 v23, 32, v21
    v_add_u32 v23, v23, v3
    v_add_u32 v80, s18, v23
    v_mul_u32_u24 v23, 32, v22
    v_lshlrev_b32 v81, 2, v20
    v_add_u32 v23, v23, v81
    v_add_u32 v81, s19, v23
    s_add_u32 s32, s14, 11534336
    s_addc_u32 s33, s15, 0
    s_mov_b32 s34, 2621440
    s_mov_b32 s35, 0x00020000
    v_add_u32 v42, 0, v0
    v_lshrrev_b32 v40, 3, v42
    v_and_b32 v41, 7, v42
    v_lshlrev_b32 v41, 3, v41
    v_mul_u32_u24 v43, 144, v40
    v_lshl_add_u32 v43, v41, 1, v43
    v_add_u32 v40, s18, v40
    v_add_u32 v41, s19, v41
    v_mul_u32_u24 v42, 1280, v40
    v_lshl_add_u32 v42, v41, 1, v42
    buffer_load_dwordx4 v[84:87], v42, s[32:35], 0 offen
    v_add_u32 v42, 512, v0
    v_lshrrev_b32 v40, 3, v42
    v_and_b32 v41, 7, v42
    v_lshlrev_b32 v41, 3, v41
    v_mul_u32_u24 v43, 144, v40
    v_lshl_add_u32 v43, v41, 1, v43
    v_add_u32 v40, s18, v40
    v_add_u32 v41, s19, v41
    v_mul_u32_u24 v42, 1280, v40
    v_lshl_add_u32 v42, v41, 1, v42
    buffer_load_dwordx4 v[88:91], v42, s[32:35], 0 offen
    s_mov_b32 s20, 0
    s_mov_b32 s21, 0
    s_mov_b32 s55, s22
    s_mov_b32 s48, 0
    s_mov_b32 s49, 0
gp_13:
    s_add_u32 m0, s55, 0
    s_nop 0
    buffer_load_dwordx4 v4, s[24:27], s20 offen lds
    s_add_u32 m0, s55, 8192
    s_nop 0
    buffer_load_dwordx4 v5, s[24:27], s20 offen lds
    s_add_u32 m0, s55, 16384
    s_nop 0
    buffer_load_dwordx4 v8, s[28:31], s21 offen lds
    s_add_u32 s20, s20, 128
    s_add_u32 s21, s21, 128
    s_add_u32 s55, s55, 24576
    s_cmp_lt_u32 s55, 98304
    s_cselect_b32 s55, s55, s22
    s_add_u32 s48, s48, 1
    s_cmp_lt_u32 s48, 3
    s_cbranch_scc1 gp_13
    s_mov_b32 s48, 0
gm_14:
    s_cmp_lt_u32 s48, 12
    s_cbranch_scc1 gw_15
    s_waitcnt vmcnt(0)
gw_15:
    s_waitcnt vmcnt(6)
    s_barrier
    v_add_u32 v24, s49, v12
    v_add_u32 v25, s49, v13
    v_add_u32 v26, s49, v14
    v_add_u32 v27, s49, v15
    v_add_u32 v28, s49, v16
    v_add_u32 v29, s49, v17
    v_add_u32 v30, s49, v18
    v_add_u32 v31, s49, v19
    ds_read_b128 v[32:35], v24 offset:0
    ds_read_b128 v[40:43], v28 offset:0
    s_cmp_lt_u32 s48, 11
    s_cbranch_scc0 gn_16
    ds_read_b128 v[36:39], v25 offset:0
    ds_read_b128 v[44:47], v29 offset:0
    s_waitcnt lgkmcnt(2)
    v_mfma_f32_32x32x16_bf16 v[64:79], v[40:43], v[32:35], v[64:79]
    s_add_u32 m0, s55, 0
    s_nop 0
    buffer_load_dwordx4 v4, s[24:27], s20 offen lds
    ds_read_b128 v[32:35], v26 offset:0
    ds_read_b128 v[40:43], v30 offset:0
    s_waitcnt lgkmcnt(2)
    v_mfma_f32_32x32x16_bf16 v[64:79], v[44:47], v[36:39], v[64:79]
    s_add_u32 m0, s55, 8192
    s_nop 0
    buffer_load_dwordx4 v5, s[24:27], s20 offen lds
    ds_read_b128 v[36:39], v27 offset:0
    ds_read_b128 v[44:47], v31 offset:0
    s_waitcnt lgkmcnt(2)
    v_mfma_f32_32x32x16_bf16 v[64:79], v[40:43], v[32:35], v[64:79]
    s_add_u32 m0, s55, 16384
    s_nop 0
    buffer_load_dwordx4 v8, s[28:31], s21 offen lds
    s_waitcnt lgkmcnt(0)
    v_mfma_f32_32x32x16_bf16 v[64:79], v[44:47], v[36:39], v[64:79]
    s_add_u32 s20, s20, 128
    s_add_u32 s21, s21, 128
    s_add_u32 s55, s55, 24576
    s_cmp_lt_u32 s55, 98304
    s_cselect_b32 s55, s55, s22
    s_branch gx_17
gn_16:
    ds_read_b128 v[36:39], v25 offset:0
    ds_read_b128 v[44:47], v29 offset:0
    s_waitcnt lgkmcnt(2)
    v_mfma_f32_32x32x16_bf16 v[64:79], v[40:43], v[32:35], v[64:79]
    ds_read_b128 v[32:35], v26 offset:0
    ds_read_b128 v[40:43], v30 offset:0
    s_waitcnt lgkmcnt(2)
    v_mfma_f32_32x32x16_bf16 v[64:79], v[44:47], v[36:39], v[64:79]
    ds_read_b128 v[36:39], v27 offset:0
    ds_read_b128 v[44:47], v31 offset:0
    s_waitcnt lgkmcnt(2)
    v_mfma_f32_32x32x16_bf16 v[64:79], v[40:43], v[32:35], v[64:79]
    s_waitcnt lgkmcnt(0)
    v_mfma_f32_32x32x16_bf16 v[64:79], v[44:47], v[36:39], v[64:79]
gx_17:
    s_add_u32 s49, s49, 24576
    s_cmp_lt_u32 s49, 98304
    s_cselect_b32 s49, s49, 0
    s_add_u32 s48, s48, 1
    s_cmp_lt_u32 s48, 14
    s_cbranch_scc1 gm_14
    s_nop 7
    s_nop 7
    s_barrier
    s_add_u32 s36, s14, 14680064
    s_addc_u32 s37, s15, 0
    s_mov_b32 s38, 2621440
    s_mov_b32 s39, 0x00020000
    s_mov_b32 s48, 0
ge_18:
    s_lshl_b32 s56, s48, 2
    s_lshr_b32 s49, s48, 2
    s_lshl_b32 s49, s49, 5
    s_lshr_b32 s55, s48, 2
    s_and_b32 s55, s55, 0
    s_lshl_b32 s55, s55, 5
    s_and_b32 s20, s48, 3
    s_lshl_b32 s20, s20, 3
    s_add_u32 s55, s55, s20
    s_set_gpr_idx_on s56, gpr_idx(SRC0)
    v_mov_b32 v40, v64
    v_mov_b32 v41, v65
    v_mov_b32 v42, v66
    v_mov_b32 v43, v67
    s_set_gpr_idx_off
    v_add_u32 v4, s49, v80
    v_add_u32 v5, s55, v81
    v_subrev_u32 v6, s18, v4
    v_mul_u32_u24 v6, 144, v6
    v_subrev_u32 v7, s19, v5
    v_lshl_add_u32 v7, v7, 1, v6
    v_cvt_pk_bf16_f32 v10, v40, v41
    v_cvt_pk_bf16_f32 v11, v42, v43
    ds_write_b64 v7, v[10:11]
    s_add_u32 s48, s48, 1
    s_cmp_lt_u32 s48, 4
    s_cbranch_scc1 ge_18
    s_waitcnt lgkmcnt(0)
    s_barrier
    v_add_u32 v6, 0, v0
    v_lshrrev_b32 v4, 3, v6
    v_and_b32 v5, 7, v6
    v_lshlrev_b32 v5, 3, v5
    v_mul_u32_u24 v7, 144, v4
    v_lshl_add_u32 v7, v5, 1, v7
    v_add_u32 v4, s18, v4
    v_add_u32 v5, s19, v5
    ds_read_b128 v[32:35], v7
    v_mul_u32_u24 v6, 1280, v4
    v_lshl_add_u32 v6, v5, 1, v6
    s_waitcnt lgkmcnt(0)
    v_lshlrev_b32 v36, 16, v32
    v_and_b32 v37, 0xffff0000, v32
    v_lshlrev_b32 v38, 16, v84
    v_and_b32 v39, 0xffff0000, v84
    v_add_f32 v36, v36, v38
    v_add_f32 v37, v37, v39
    v_cvt_pk_bf16_f32 v84, v36, v37
    v_lshlrev_b32 v36, 16, v33
    v_and_b32 v37, 0xffff0000, v33
    v_lshlrev_b32 v38, 16, v85
    v_and_b32 v39, 0xffff0000, v85
    v_add_f32 v36, v36, v38
    v_add_f32 v37, v37, v39
    v_cvt_pk_bf16_f32 v85, v36, v37
    v_lshlrev_b32 v36, 16, v34
    v_and_b32 v37, 0xffff0000, v34
    v_lshlrev_b32 v38, 16, v86
    v_and_b32 v39, 0xffff0000, v86
    v_add_f32 v36, v36, v38
    v_add_f32 v37, v37, v39
    v_cvt_pk_bf16_f32 v86, v36, v37
    v_lshlrev_b32 v36, 16, v35
    v_and_b32 v37, 0xffff0000, v35
    v_lshlrev_b32 v38, 16, v87
    v_and_b32 v39, 0xffff0000, v87
    v_add_f32 v36, v36, v38
    v_add_f32 v37, v37, v39
    v_cvt_pk_bf16_f32 v87, v36, v37
    buffer_store_dwordx4 v[84:87], v6, s[36:39], 0 offen
    v_add_u32 v6, 512, v0
    v_lshrrev_b32 v4, 3, v6
    v_and_b32 v5, 7, v6
    v_lshlrev_b32 v5, 3, v5
    v_mul_u32_u24 v7, 144, v4
    v_lshl_add_u32 v7, v5, 1, v7
    v_add_u32 v4, s18, v4
    v_add_u32 v5, s19, v5
    ds_read_b128 v[32:35], v7
    v_mul_u32_u24 v6, 1280, v4
    v_lshl_add_u32 v6, v5, 1, v6
    s_waitcnt lgkmcnt(0)
    v_lshlrev_b32 v36, 16, v32
    v_and_b32 v37, 0xffff0000, v32
    v_lshlrev_b32 v38, 16, v88
    v_and_b32 v39, 0xffff0000, v88
    v_add_f32 v36, v36, v38
    v_add_f32 v37, v37, v39
    v_cvt_pk_bf16_f32 v88, v36, v37
    v_lshlrev_b32 v36, 16, v33
    v_and_b32 v37, 0xffff0000, v33
    v_lshlrev_b32 v38, 16, v89
    v_and_b32 v39, 0xffff0000, v89
    v_add_f32 v36, v36, v38
    v_add_f32 v37, v37, v39
    v_cvt_pk_bf16_f32 v89, v36, v37
    v_lshlrev_b32 v36, 16, v34
    v_and_b32 v37, 0xffff0000, v34
    v_lshlrev_b32 v38, 16, v90
    v_and_b32 v39, 0xffff0000, v90
    v_add_f32 v36, v36, v38
    v_add_f32 v37, v37, v39
    v_cvt_pk_bf16_f32 v90, v36, v37
    v_lshlrev_b32 v36, 16, v35
    v_and_b32 v37, 0xffff0000, v35
    v_lshlrev_b32 v38, 16, v91
    v_and_b32 v39, 0xffff0000, v91
    v_add_f32 v36, v36, v38
    v_add_f32 v37, v37, v39
    v_cvt_pk_bf16_f32 v91, v36, v37
    buffer_store_dwordx4 v[88:91], v6, s[36:39], 0 offen
    s_waitcnt vmcnt(0)
gemm3a_kernel_done:
    s_endpgm
.globl gemm3b_kernel
.p2align 8
.type gemm3b_kernel,@function
gemm3b_kernel:
    s_cmp_ge_u32 s2, 160
    s_cbranch_scc1 gemm3b_kernel_done
    s_load_dwordx2 s[4:5], s[0:1], 104
    s_load_dwordx2 s[6:7], s[0:1], 104
    s_load_dwordx2 s[14:15], s[0:1], 104
    s_load_dwordx2 s[10:11], s[0:1], 72
    s_load_dwordx2 s[12:13], s[0:1], 88
    s_and_b32 s16, s2, 15
    s_lshr_b32 s17, s2, 4
    s_mul_i32 s18, s16, 128
    s_mul_i32 s19, s17, 64
    v_lshrrev_b32 v1, 6, v0
    v_lshlrev_b32 v1, 10, v1
    s_nop 0
    v_readfirstlane_b32 s22, v1
    s_waitcnt lgkmcnt(0)
    s_add_u32 s24, s4, 35651584
    s_addc_u32 s25, s5, 0
    s_mov_b32 s26, 3670016
    s_mov_b32 s27, 0x00020000
    s_add_u32 s28, s6, 9437184
    s_addc_u32 s29, s7, 0
    s_mov_b32 s30, 1146880
    s_mov_b32 s31, 0x00020000
    v_lshrrev_b32 v1, 3, v0
    v_and_b32 v2, 7, v0
    v_lshrrev_b32 v3, 1, v1
    v_and_b32 v3, 7, v3
    v_xor_b32 v2, v2, v3
    v_lshlrev_b32 v2, 4, v2
    v_add_u32 v3, s18, v1
    v_mul_u32_u24 v3, 1792, v3
    v_add_u32 v4, v3, v2
    v_add_u32 v3, s19, v1
    v_mul_u32_u24 v3, 1792, v3
    v_mul_u32_u24 v9, 1, v2
    v_add_u32 v8, v3, v9
    v_add_u32 v5, 114688, v4
    v_lshrrev_b32 v1, 6, v0
    v_and_b32 v2, 63, v0
    v_and_b32 v3, 31, v2
    v_lshrrev_b32 v20, 5, v2
    v_and_b32 v21, 3, v1
    v_lshrrev_b32 v22, 2, v1
    v_mul_u32_u24 v23, 32, v21
    v_add_u32 v23, v23, v3
    v_lshrrev_b32 v12, 1, v23
    v_and_b32 v12, 7, v12
    v_xor_b32 v12, v12, v20
    v_mul_u32_u24 v23, 128, v23
    v_xor_b32 v15, 6, v12
    v_lshl_add_u32 v15, v15, 4, v23
    v_xor_b32 v14, 4, v12
    v_lshl_add_u32 v14, v14, 4, v23
    v_xor_b32 v13, 2, v12
    v_lshl_add_u32 v13, v13, 4, v23
    v_xor_b32 v12, 0, v12
    v_lshl_add_u32 v12, v12, 4, v23
    v_mul_u32_u24 v23, 32, v22
    v_add_u32 v23, v23, v3
    v_lshrrev_b32 v16, 1, v23
    v_and_b32 v16, 7, v16
    v_xor_b32 v16, v16, v20
    v_mul_u32_u24 v23, 128, v23
    v_add_u32 v23, 16384, v23
    v_xor_b32 v19, 6, v16
    v_lshl_add_u32 v19, v19, 4, v23
    v_xor_b32 v18, 4, v16
    v_lshl_add_u32 v18, v18, 4, v23
    v_xor_b32 v17, 2, v16
    v_lshl_add_u32 v17, v17, 4, v23
    v_xor_b32 v16, 0, v16
    v_lshl_add_u32 v16, v16, 4, v23
    v_mov_b32 v64, 0
    v_mov_b32 v65, 0
    v_mov_b32 v66, 0
    v_mov_b32 v67, 0
    v_mov_b32 v68, 0
    v_mov_b32 v69, 0
    v_mov_b32 v70, 0
    v_mov_b32 v71, 0
    v_mov_b32 v72, 0
    v_mov_b32 v73, 0
    v_mov_b32 v74, 0
    v_mov_b32 v75, 0
    v_mov_b32 v76, 0
    v_mov_b32 v77, 0
    v_mov_b32 v78, 0
    v_mov_b32 v79, 0
    v_mul_u32_u24 v23, 32, v21
    v_add_u32 v23, v23, v3
    v_add_u32 v80, s18, v23
    v_mul_u32_u24 v23, 32, v22
    v_lshlrev_b32 v81, 2, v20
    v_add_u32 v23, v23, v81
    v_add_u32 v81, s19, v23
    s_add_u32 s32, s14, 17825792
    s_addc_u32 s33, s15, 0
    s_mov_b32 s34, 2621440
    s_mov_b32 s35, 0x00020000
    v_add_u32 v42, 0, v0
    v_lshrrev_b32 v40, 3, v42
    v_and_b32 v41, 7, v42
    v_lshlrev_b32 v41, 3, v41
    v_mul_u32_u24 v43, 144, v40
    v_lshl_add_u32 v43, v41, 1, v43
    v_add_u32 v40, s18, v40
    v_add_u32 v41, s19, v41
    v_mul_u32_u24 v42, 1280, v40
    v_lshl_add_u32 v42, v41, 1, v42
    buffer_load_dwordx4 v[84:87], v42, s[32:35], 0 offen
    v_add_u32 v42, 512, v0
    v_lshrrev_b32 v40, 3, v42
    v_and_b32 v41, 7, v42
    v_lshlrev_b32 v41, 3, v41
    v_mul_u32_u24 v43, 144, v40
    v_lshl_add_u32 v43, v41, 1, v43
    v_add_u32 v40, s18, v40
    v_add_u32 v41, s19, v41
    v_mul_u32_u24 v42, 1280, v40
    v_lshl_add_u32 v42, v41, 1, v42
    buffer_load_dwordx4 v[88:91], v42, s[32:35], 0 offen
    s_mov_b32 s20, 0
    s_mov_b32 s21, 0
    s_mov_b32 s55, s22
    s_mov_b32 s48, 0
    s_mov_b32 s49, 0
gp_19:
    s_add_u32 m0, s55, 0
    s_nop 0
    buffer_load_dwordx4 v4, s[24:27], s20 offen lds
    s_add_u32 m0, s55, 8192
    s_nop 0
    buffer_load_dwordx4 v5, s[24:27], s20 offen lds
    s_add_u32 m0, s55, 16384
    s_nop 0
    buffer_load_dwordx4 v8, s[28:31], s21 offen lds
    s_add_u32 s20, s20, 128
    s_add_u32 s21, s21, 128
    s_add_u32 s55, s55, 24576
    s_cmp_lt_u32 s55, 98304
    s_cselect_b32 s55, s55, s22
    s_add_u32 s48, s48, 1
    s_cmp_lt_u32 s48, 3
    s_cbranch_scc1 gp_19
    s_mov_b32 s48, 0
gm_20:
    s_cmp_lt_u32 s48, 12
    s_cbranch_scc1 gw_21
    s_waitcnt vmcnt(0)
gw_21:
    s_waitcnt vmcnt(6)
    s_barrier
    v_add_u32 v24, s49, v12
    v_add_u32 v25, s49, v13
    v_add_u32 v26, s49, v14
    v_add_u32 v27, s49, v15
    v_add_u32 v28, s49, v16
    v_add_u32 v29, s49, v17
    v_add_u32 v30, s49, v18
    v_add_u32 v31, s49, v19
    ds_read_b128 v[32:35], v24 offset:0
    ds_read_b128 v[40:43], v28 offset:0
    s_cmp_lt_u32 s48, 11
    s_cbranch_scc0 gn_22
    ds_read_b128 v[36:39], v25 offset:0
    ds_read_b128 v[44:47], v29 offset:0
    s_waitcnt lgkmcnt(2)
    v_mfma_f32_32x32x16_bf16 v[64:79], v[40:43], v[32:35], v[64:79]
    s_add_u32 m0, s55, 0
    s_nop 0
    buffer_load_dwordx4 v4, s[24:27], s20 offen lds
    ds_read_b128 v[32:35], v26 offset:0
    ds_read_b128 v[40:43], v30 offset:0
    s_waitcnt lgkmcnt(2)
    v_mfma_f32_32x32x16_bf16 v[64:79], v[44:47], v[36:39], v[64:79]
    s_add_u32 m0, s55, 8192
    s_nop 0
    buffer_load_dwordx4 v5, s[24:27], s20 offen lds
    ds_read_b128 v[36:39], v27 offset:0
    ds_read_b128 v[44:47], v31 offset:0
    s_waitcnt lgkmcnt(2)
    v_mfma_f32_32x32x16_bf16 v[64:79], v[40:43], v[32:35], v[64:79]
    s_add_u32 m0, s55, 16384
    s_nop 0
    buffer_load_dwordx4 v8, s[28:31], s21 offen lds
    s_waitcnt lgkmcnt(0)
    v_mfma_f32_32x32x16_bf16 v[64:79], v[44:47], v[36:39], v[64:79]
    s_add_u32 s20, s20, 128
    s_add_u32 s21, s21, 128
    s_add_u32 s55, s55, 24576
    s_cmp_lt_u32 s55, 98304
    s_cselect_b32 s55, s55, s22
    s_branch gx_23
gn_22:
    ds_read_b128 v[36:39], v25 offset:0
    ds_read_b128 v[44:47], v29 offset:0
    s_waitcnt lgkmcnt(2)
    v_mfma_f32_32x32x16_bf16 v[64:79], v[40:43], v[32:35], v[64:79]
    ds_read_b128 v[32:35], v26 offset:0
    ds_read_b128 v[40:43], v30 offset:0
    s_waitcnt lgkmcnt(2)
    v_mfma_f32_32x32x16_bf16 v[64:79], v[44:47], v[36:39], v[64:79]
    ds_read_b128 v[36:39], v27 offset:0
    ds_read_b128 v[44:47], v31 offset:0
    s_waitcnt lgkmcnt(2)
    v_mfma_f32_32x32x16_bf16 v[64:79], v[40:43], v[32:35], v[64:79]
    s_waitcnt lgkmcnt(0)
    v_mfma_f32_32x32x16_bf16 v[64:79], v[44:47], v[36:39], v[64:79]
gx_23:
    s_add_u32 s49, s49, 24576
    s_cmp_lt_u32 s49, 98304
    s_cselect_b32 s49, s49, 0
    s_add_u32 s48, s48, 1
    s_cmp_lt_u32 s48, 14
    s_cbranch_scc1 gm_20
    s_nop 7
    s_nop 7
    s_barrier
    s_mov_b32 s36, s12
    s_mov_b32 s37, s13
    s_mov_b32 s38, 2621440
    s_mov_b32 s39, 0x00020000
    s_mov_b32 s48, 0
ge_24:
    s_lshl_b32 s56, s48, 2
    s_lshr_b32 s49, s48, 2
    s_lshl_b32 s49, s49, 5
    s_lshr_b32 s55, s48, 2
    s_and_b32 s55, s55, 0
    s_lshl_b32 s55, s55, 5
    s_and_b32 s20, s48, 3
    s_lshl_b32 s20, s20, 3
    s_add_u32 s55, s55, s20
    s_set_gpr_idx_on s56, gpr_idx(SRC0)
    v_mov_b32 v40, v64
    v_mov_b32 v41, v65
    v_mov_b32 v42, v66
    v_mov_b32 v43, v67
    s_set_gpr_idx_off
    v_add_u32 v4, s49, v80
    v_add_u32 v5, s55, v81
    v_subrev_u32 v6, s18, v4
    v_mul_u32_u24 v6, 144, v6
    v_subrev_u32 v7, s19, v5
    v_lshl_add_u32 v7, v7, 1, v6
    v_cvt_pk_bf16_f32 v10, v40, v41
    v_cvt_pk_bf16_f32 v11, v42, v43
    ds_write_b64 v7, v[10:11]
    s_add_u32 s48, s48, 1
    s_cmp_lt_u32 s48, 4
    s_cbranch_scc1 ge_24
    s_waitcnt lgkmcnt(0)
    s_barrier
    v_add_u32 v6, 0, v0
    v_lshrrev_b32 v4, 3, v6
    v_and_b32 v5, 7, v6
    v_lshlrev_b32 v5, 3, v5
    v_mul_u32_u24 v7, 144, v4
    v_lshl_add_u32 v7, v5, 1, v7
    v_add_u32 v4, s18, v4
    v_add_u32 v5, s19, v5
    ds_read_b128 v[32:35], v7
    v_mul_u32_u24 v6, 1280, v4
    v_lshl_add_u32 v6, v5, 1, v6
    s_waitcnt lgkmcnt(0)
    v_lshlrev_b32 v36, 16, v32
    v_and_b32 v37, 0xffff0000, v32
    v_lshlrev_b32 v38, 16, v84
    v_and_b32 v39, 0xffff0000, v84
    v_add_f32 v36, v36, v38
    v_add_f32 v37, v37, v39
    v_cvt_pk_bf16_f32 v84, v36, v37
    v_lshlrev_b32 v36, 16, v33
    v_and_b32 v37, 0xffff0000, v33
    v_lshlrev_b32 v38, 16, v85
    v_and_b32 v39, 0xffff0000, v85
    v_add_f32 v36, v36, v38
    v_add_f32 v37, v37, v39
    v_cvt_pk_bf16_f32 v85, v36, v37
    v_lshlrev_b32 v36, 16, v34
    v_and_b32 v37, 0xffff0000, v34
    v_lshlrev_b32 v38, 16, v86
    v_and_b32 v39, 0xffff0000, v86
    v_add_f32 v36, v36, v38
    v_add_f32 v37, v37, v39
    v_cvt_pk_bf16_f32 v86, v36, v37
    v_lshlrev_b32 v36, 16, v35
    v_and_b32 v37, 0xffff0000, v35
    v_lshlrev_b32 v38, 16, v87
    v_and_b32 v39, 0xffff0000, v87
    v_add_f32 v36, v36, v38
    v_add_f32 v37, v37, v39
    v_cvt_pk_bf16_f32 v87, v36, v37
    buffer_store_dwordx4 v[84:87], v6, s[36:39], 0 offen
    v_add_u32 v6, 512, v0
    v_lshrrev_b32 v4, 3, v6
    v_and_b32 v5, 7, v6
    v_lshlrev_b32 v5, 3, v5
    v_mul_u32_u24 v7, 144, v4
    v_lshl_add_u32 v7, v5, 1, v7
    v_add_u32 v4, s18, v4
    v_add_u32 v5, s19, v5
    ds_read_b128 v[32:35], v7
    v_mul_u32_u24 v6, 1280, v4
    v_lshl_add_u32 v6, v5, 1, v6
    s_waitcnt lgkmcnt(0)
    v_lshlrev_b32 v36, 16, v32
    v_and_b32 v37, 0xffff0000, v32
    v_lshlrev_b32 v38, 16, v88
    v_and_b32 v39, 0xffff0000, v88
    v_add_f32 v36, v36, v38
    v_add_f32 v37, v37, v39
    v_cvt_pk_bf16_f32 v88, v36, v37
    v_lshlrev_b32 v36, 16, v33
    v_and_b32 v37, 0xffff0000, v33
    v_lshlrev_b32 v38, 16, v89
    v_and_b32 v39, 0xffff0000, v89
    v_add_f32 v36, v36, v38
    v_add_f32 v37, v37, v39
    v_cvt_pk_bf16_f32 v89, v36, v37
    v_lshlrev_b32 v36, 16, v34
    v_and_b32 v37, 0xffff0000, v34
    v_lshlrev_b32 v38, 16, v90
    v_and_b32 v39, 0xffff0000, v90
    v_add_f32 v36, v36, v38
    v_add_f32 v37, v37, v39
    v_cvt_pk_bf16_f32 v90, v36, v37
    v_lshlrev_b32 v36, 16, v35
    v_and_b32 v37, 0xffff0000, v35
    v_lshlrev_b32 v38, 16, v91
    v_and_b32 v39, 0xffff0000, v91
    v_add_f32 v36, v36, v38
    v_add_f32 v37, v37, v39
    v_cvt_pk_bf16_f32 v91, v36, v37
    buffer_store_dwordx4 v[88:91], v6, s[36:39], 0 offen
    s_waitcnt vmcnt(0)
gemm3b_kernel_done:
    s_endpgm
.section .rodata,"a"
.p2align 6
.amdhsa_kernel prep_kernel
  .amdhsa_next_free_vgpr 64
  .amdhsa_next_free_sgpr 48
  .amdhsa_accum_offset 64
  .amdhsa_group_segment_fixed_size 0
  .amdhsa_kernarg_size 112
  .amdhsa_user_sgpr_count 2
  .amdhsa_user_sgpr_kernarg_segment_ptr 1
  .amdhsa_system_sgpr_workgroup_id_x 1
.end_amdhsa_kernel
.p2align 6
.amdhsa_kernel conv_kernel
  .amdhsa_next_free_vgpr 96
  .amdhsa_next_free_sgpr 80
  .amdhsa_accum_offset 96
  .amdhsa_group_segment_fixed_size 0
  .amdhsa_kernarg_size 112
  .amdhsa_user_sgpr_count 2
  .amdhsa_user_sgpr_kernarg_segment_ptr 1
  .amdhsa_system_sgpr_workgroup_id_x 1
.end_amdhsa_kernel
.p2align 6
.amdhsa_kernel rowa_kernel
  .amdhsa_next_free_vgpr 64
  .amdhsa_next_free_sgpr 64
  .amdhsa_accum_offset 64
  .amdhsa_group_segment_fixed_size 0
  .amdhsa_kernarg_size 112
  .amdhsa_user_sgpr_count 2
  .amdhsa_user_sgpr_kernarg_segment_ptr 1
  .amdhsa_system_sgpr_workgroup_id_x 1
.end_amdhsa_kernel
.p2align 6
.amdhsa_kernel rowb_kernel
  .amdhsa_next_free_vgpr 64
  .amdhsa_next_free_sgpr 64
  .amdhsa_accum_offset 64
  .amdhsa_group_segment_fixed_size 0
  .amdhsa_kernarg_size 112
  .amdhsa_user_sgpr_count 2
  .amdhsa_user_sgpr_kernarg_segment_ptr 1
  .amdhsa_system_sgpr_workgroup_id_x 1
.end_amdhsa_kernel
.p2align 6
.amdhsa_kernel lnz_kernel
  .amdhsa_next_free_vgpr 64
  .amdhsa_next_free_sgpr 64
  .amdhsa_accum_offset 64
  .amdhsa_group_segment_fixed_size 0
  .amdhsa_kernarg_size 112
  .amdhsa_user_sgpr_count 2
  .amdhsa_user_sgpr_kernarg_segment_ptr 1
  .amdhsa_system_sgpr_workgroup_id_x 1
.end_amdhsa_kernel
.p2align 6
.amdhsa_kernel gemm1_kernel
  .amdhsa_next_free_vgpr 124
  .amdhsa_next_free_sgpr 80
  .amdhsa_accum_offset 124
  .amdhsa_group_segment_fixed_size 0
  .amdhsa_kernarg_size 112
  .amdhsa_user_sgpr_count 2
  .amdhsa_user_sgpr_kernarg_segment_ptr 1
  .amdhsa_system_sgpr_workgroup_id_x 1
.end_amdhsa_kernel
.p2align 6
.amdhsa_kernel gemm2_kernel
  .amdhsa_next_free_vgpr 108
  .amdhsa_next_free_sgpr 80
  .amdhsa_accum_offset 108
  .amdhsa_group_segment_fixed_size 0
  .amdhsa_kernarg_size 112
  .amdhsa_user_sgpr_count 2
  .amdhsa_user_sgpr_kernarg_segment_ptr 1
  .amdhsa_system_sgpr_workgroup_id_x 1
.end_amdhsa_kernel
.p2align 6
.amdhsa_kernel gemm3a_kernel
  .amdhsa_next_free_vgpr 108
  .amdhsa_next_free_sgpr 80
  .amdhsa_accum_offset 108
  .amdhsa_group_segment_fixed_size 0
  .amdhsa_kernarg_size 112
  .amdhsa_user_sgpr_count 2
  .amdhsa_user_sgpr_kernarg_segment_ptr 1
  .amdhsa_system_sgpr_workgroup_id_x 1
.end_amdhsa_kernel
.p2align 6
.amdhsa_kernel gemm3b_kernel
  .amdhsa_next_free_vgpr 108
  .amdhsa_next_free_sgpr 80
  .amdhsa_accum_offset 108
  .amdhsa_group_segment_fixed_size 0
  .amdhsa_kernarg_size 112
  .amdhsa_user_sgpr_count 2
  .amdhsa_user_sgpr_kernarg_segment_ptr 1
  .amdhsa_system_sgpr_workgroup_id_x 1
.end_amdhsa_kernel
```
